```python
import torch

def _softmax(x, axis=-1):
    return torch.softmax(x, dim=axis)
def _gelu(x):
    return torch.nn.functional.gelu(x, approximate="tanh")
def _silu(x):
    return torch.nn.functional.silu(x)
def _sigmoid(x):
    return torch.sigmoid(x)
def _layernorm(x, axis=-1, eps=1e-5):
    m = x.mean(dim=axis, keepdim=True)
    v = x.var(dim=axis, keepdim=True, unbiased=False)
    return (x - m) / torch.sqrt(v + eps)
def _scatter_add(tgt, idx, src, axis=0):
    return tgt.clone().index_add_(axis, idx, src)
def _segment_sum(src, seg, n):
    out = torch.zeros((n,) + src.shape[1:], dtype=src.dtype)
    return out.index_add_(0, seg, src)
def _pad(x, pw):
    flat = tuple(v for pair in reversed(pw) for v in pair)
    return torch.nn.functional.pad(x, flat)

kernel_name = 'parallel_sum__sliding_block_cached__geglu_ffn__decode'

def setup_inputs():

    _w = (lambda a: (lambda t: t.to(torch.bfloat16) if t.is_floating_point() else t)(torch.as_tensor(a)))
    def _A_setup():
        B, Sq, D = 2, 1, 576
        Hq, Hkv, Sk, Dh = 32, 16, 4096, 128
        assert Hq % Hkv == 0, (Hq, Hkv)
        return {
            "x": _w((lambda *s: torch.randn(*s, dtype=torch.bfloat16) * 0.05)(B, Sq, D)),
            "k_cache": _w((lambda *s: torch.randn(*s, dtype=torch.bfloat16) * 3.2)(B, Hkv, Sk, Dh)),
            "v_cache": _w((lambda *s: torch.randn(*s, dtype=torch.bfloat16) * 1.6)(B, Hkv, Sk, Dh)),
            "wq": _w((lambda *s: torch.randn(*s, dtype=torch.bfloat16) * 3.2)(D, Hq * Dh) * (D ** -0.5)),
            "wo": _w((lambda *s: torch.randn(*s, dtype=torch.bfloat16) * 1.6)(Hq * Dh, D) * ((Hq * Dh) ** -0.5)),
        }
    _A_in = _A_setup()

    def _B_setup():
        B, S, D, F = 2, 1, 576, 4608
        return {
            "x": _w((lambda *s: torch.randn(*s, dtype=torch.bfloat16) * 0.05)(B, S, D)),
            "w_gate": _w((lambda *s: torch.randn(*s, dtype=torch.bfloat16) * 0.05)(D, F)),
            "w_up": _w((lambda *s: torch.randn(*s, dtype=torch.bfloat16) * 0.05)(D, F)),
            "w_down": _w((lambda *s: torch.randn(*s, dtype=torch.bfloat16) * 0.05)(F, D)),
        }
    _B_in = _B_setup()

    return {
        "A_x": _A_in["x"],
        "A_k_cache": _A_in["k_cache"],
        "A_v_cache": _A_in["v_cache"],
        "A_wq": _A_in["wq"],
        "A_wo": _A_in["wo"],
        "B_x": _B_in["x"],
        "B_w_gate": _B_in["w_gate"],
        "B_w_up": _B_in["w_up"],
        "B_w_down": _B_in["w_down"],
    }

def reference(A_x, A_k_cache, A_v_cache, A_wq, A_wo, B_x, B_w_gate, B_w_up, B_w_down):
    def _A_ref(x, k_cache, v_cache, wq, wo):
        B, Sq, D = x.shape
        Hq, Dh = 32, 128
        Hkv, Sk = k_cache.shape[1], k_cache.shape[2]
        W = min(4096, max(256, Sk // 4))
        rep = Hq // Hkv
        q = (lambda x, *d: x.permute(*d))((x @ wq).reshape(B, Sq, Hq, Dh), 0, 2, 1, 3)
        k = (lambda x, n, axis: torch.repeat_interleave(x, n, dim=axis))(k_cache[:, :, Sk - W:, :], rep, axis=1)
        v = (lambda x, n, axis: torch.repeat_interleave(x, n, dim=axis))(v_cache[:, :, Sk - W:, :], rep, axis=1)
        scores = torch.einsum("bhqd,bhkd->bhqk", q, k) * (Dh ** -0.5)
        p = _softmax(scores, axis=-1)
        o = torch.einsum("bhqk,bhkd->bhqd", p, v)
        return (lambda x, *d: x.permute(*d))(o, 0, 2, 1, 3).reshape(B, Sq, Hq * Dh) @ wo

    def _B_ref(x, w_gate, w_up, w_down):
        return (_gelu(x @ w_gate) * (x @ w_up)) @ w_down

    x = A_x
    xn = _layernorm(x, axis=-1)
    return x + _A_ref(xn, A_k_cache, A_v_cache, A_wq, A_wo) + _B_ref(xn, B_w_gate, B_w_up, B_w_down)
```

```asm
; @launch grid=(256,1,1) block=(576,1,1) lds=163840
.amdgcn_target "amdgcn-amd-amdhsa--gfx950"
.text
.globl parallel_sum__sliding_block_cached__geglu_ffn__decode_kernel
.p2align 8
.type parallel_sum__sliding_block_cached__geglu_ffn__decode_kernel,@function
parallel_sum__sliding_block_cached__geglu_ffn__decode_kernel:
    s_load_dwordx2 s[48:49], s[0:1], 24
    s_cmp_ge_u32 s2, 256
    s_cbranch_scc1 L_end
    v_lshrrev_b32 v1, 6, v0
    v_and_b32 v0, 63, v0
    v_mov_b32 v3, 0
    v_readfirstlane_b32 s32, v1
    s_and_b32 s28, s2, 7
    s_lshr_b32 s29, s2, 3
    s_lshr_b32 s40, s2, 7
    s_lshl1_add_u32 s30, s28, s40
    s_and_b32 s31, s29, 15
    s_cmp_eq_u32 s32, 0
    s_cbranch_scc1 L_loader
    s_load_dwordx16 s[4:19], s[0:1], 0
    s_load_dwordx8 s[20:27], s[0:1], 64
    s_cmp_lg_u32 s32, 8
    s_cbranch_scc1 LCP_1
    s_lshl_b32 s40, s31, 10
    s_cmp_ge_u32 s40, L_code_end-parallel_sum__sliding_block_cached__geglu_ffn__decode_kernel
    s_cbranch_scc1 LCP_1
    s_getpc_b64 s[88:89]
L_pc:
    s_sub_u32 s88, s88, L_pc-parallel_sum__sliding_block_cached__geglu_ffn__decode_kernel
    s_subb_u32 s89, s89, 0
    v_lshlrev_b32 v4, 4, v0
    v_add_u32 v4, s40, v4
    global_load_dwordx4 v[76:79], v4, s[88:89]
LCP_1:
    v_mul_u32_u24 v13, 36, v0
    s_cmp_ge_u32 s32, 5
    s_waitcnt lgkmcnt(0)
    s_load_dword s46, s[26:27], 0
    s_cbranch_scc1 L_cons2
    global_load_dwordx4 v[16:19], v13, s[4:5]
    global_load_dwordx4 v[20:23], v13, s[4:5] offset:16
    global_load_dword v24, v13, s[4:5] offset:32
L_cons2:
    s_branch L_cons3
L_loader:
    v_lshrrev_b32 v8, 3, v0
    v_lshrrev_b32 v15, 4, v0
    v_lshlrev_b32 v9, 1, v15
    v_and_b32 v10, 7, v0
    v_xor_b32 v10, v10, v9
    v_lshlrev_b32 v10, 4, v10
    v_lshl_add_u32 v16, v8, 13, v10
    s_and_b32 s40, s29, 3
    s_mul_i32 s90, s40, 1179648
    s_lshr_b32 s40, s29, 2
    s_xor_b32 s40, s40, 4
    s_lshl3_add_u32 s40, s28, s40
    s_lshl_b32 s40, s40, 7
    s_add_u32 s90, s90, s40
    s_mov_b32 s50, 0x480000
    s_mov_b32 s51, 0x00020000
    s_movk_i32 s101, 0x400
    s_mov_b32 s42, 0x10000
    s_mov_b32 m0, 55296
    s_setprio 3
    s_waitcnt lgkmcnt(0)
    buffer_load_dwordx4 v16, s[48:51], s90 offen nt lds
    s_load_dwordx16 s[4:19], s[0:1], 0
    s_load_dwordx8 s[20:27], s[0:1], 64
    s_add_u32 m0, m0, s101
    s_add_u32 s90, s90, s42
    v_mov_b32 v4, 0
    buffer_load_dwordx4 v16, s[48:51], s90 offen nt lds
    s_add_u32 m0, m0, s101
    s_add_u32 s90, s90, s42
    v_mov_b32 v5, 0
    buffer_load_dwordx4 v16, s[48:51], s90 offen nt lds
    s_add_u32 m0, m0, s101
    s_add_u32 s90, s90, s42
    v_lshlrev_b32 v2, 3, v0
    buffer_load_dwordx4 v16, s[48:51], s90 offen nt lds
    s_add_u32 m0, m0, s101
    s_add_u32 s90, s90, s42
    ds_write_b64 v2, v[4:5]
    buffer_load_dwordx4 v16, s[48:51], s90 offen nt lds
    s_add_u32 m0, m0, s101
    s_add_u32 s90, s90, s42
    v_xor_b32 v13, v0, v15
    buffer_load_dwordx4 v16, s[48:51], s90 offen nt lds
    s_add_u32 m0, m0, s101
    s_add_u32 s90, s90, s42
    v_lshlrev_b32 v13, 4, v13
    buffer_load_dwordx4 v16, s[48:51], s90 offen nt lds
    s_add_u32 m0, m0, s101
    s_add_u32 s90, s90, s42
    s_mov_b32 s54, 0x2000000
    buffer_load_dwordx4 v16, s[48:51], s90 offen nt lds
    s_add_u32 m0, m0, s101
    s_add_u32 s90, s90, s42
    s_mov_b32 s55, 0x00020000
    buffer_load_dwordx4 v16, s[48:51], s90 offen nt lds
    s_add_u32 m0, m0, s101
    s_add_u32 s90, s90, s42
    s_lshr_b32 s40, s31, 3
    buffer_load_dwordx4 v16, s[48:51], s90 offen nt lds
    s_add_u32 m0, m0, s101
    s_add_u32 s90, s90, s42
    s_lshl4_add_u32 s40, s40, s30
    buffer_load_dwordx4 v16, s[48:51], s90 offen nt lds
    s_add_u32 m0, m0, s101
    s_add_u32 s90, s90, s42
    s_lshl_b32 s40, s40, 20
    buffer_load_dwordx4 v16, s[48:51], s90 offen nt lds
    s_add_u32 m0, m0, s101
    s_add_u32 s90, s90, s42
    s_and_b32 s41, s31, 7
    buffer_load_dwordx4 v16, s[48:51], s90 offen nt lds
    s_add_u32 m0, m0, s101
    s_add_u32 s90, s90, s42
    s_lshl_b32 s41, s41, 15
    buffer_load_dwordx4 v16, s[48:51], s90 offen nt lds
    s_add_u32 m0, m0, s101
    s_add_u32 s90, s90, s42
    s_add_u32 s40, s40, s41
    buffer_load_dwordx4 v16, s[48:51], s90 offen nt lds
    s_add_u32 m0, m0, s101
    s_add_u32 s90, s90, s42
    s_add_u32 s93, s40, 0xc0000
    buffer_load_dwordx4 v16, s[48:51], s90 offen nt lds
    s_add_u32 m0, m0, s101
    s_add_u32 s90, s90, s42
    s_and_b32 s98, s29, 7
    buffer_load_dwordx4 v16, s[48:51], s90 offen nt lds
    s_add_u32 m0, m0, s101
    s_add_u32 s90, s90, s42
    s_nop 0
    buffer_load_dwordx4 v16, s[48:51], s90 offen nt lds
    s_waitcnt lgkmcnt(0)
    s_mov_b32 s52, s6
    s_mov_b32 s53, s7
    s_mov_b32 s88, 92160
    s_mov_b32 m0, s88
    s_add_u32 s88, s88, 4352
    s_lshl_b32 s41, s98, 12
    s_add_u32 s41, s41, s93
    buffer_load_dwordx4 v13, s[52:55], s41 offen nt lds
    s_add_u32 m0, m0, 1088
    s_add_u32 s41, s41, s101
    buffer_load_dwordx4 v13, s[52:55], s41 offen nt lds
    s_add_u32 m0, m0, 1088
    s_add_u32 s41, s41, s101
    buffer_load_dwordx4 v13, s[52:55], s41 offen nt lds
    s_add_u32 m0, m0, 1088
    s_add_u32 s41, s41, s101
    buffer_load_dwordx4 v13, s[52:55], s41 offen nt lds
    s_add_u32 s98, s98, 1
    s_and_b32 s98, s98, 7
    s_waitcnt lgkmcnt(0)
    s_barrier
    v_mul_u32_u24 v12, 1152, v8
    v_add_u32 v12, v12, v10
    v_mul_u32_u24 v11, 9216, v8
    v_add_u32 v11, v11, v10
    v_xor_b32 v14, v0, v9
    v_lshlrev_b32 v14, 4, v14
    s_mov_b32 s56, s8
    s_mov_b32 s57, s9
    s_mov_b32 s58, 0x2000000
    s_mov_b32 s59, 0x00020000
    s_mov_b32 s92, 2
    s_mov_b32 s33, s29
    s_lshl_b32 s37, s29, 8
    s_sub_u32 s40, s29, 16
    s_mul_i32 s40, s40, 288
    s_cmp_lt_u32 s29, 16
    s_cselect_b32 s37, s37, s40
    s_cselect_b32 s35, 8, 9
    s_cmp_eq_u32 s28, 7
    s_cselect_b32 s40, 1, 0
    s_lshl_b32 s35, s35, s40
    s_mul_i32 s40, s28, 31
    s_add_u32 s40, s40, s29
    s_cmp_eq_u32 s29, 31
    s_cselect_b32 s40, 255, s40
    s_mul_i32 s38, s40, 171
    s_lshr_b32 s38, s38, 9
    s_mul_i32 s41, s38, 3
    s_sub_u32 s39, s40, s41
    s_mov_b32 s36, 130
    s_cmp_lt_u32 s40, 216
    s_cselect_b32 s36, s36, 82
    s_lshl2_add_u32 s34, s35, s36
    s_cmp_lt_u32 s33, 16
    s_cselect_b32 s60, s12, s20
    s_cselect_b32 s61, s13, s21
    s_mov_b32 s62, 0x510000
    s_cselect_b32 s62, 0x480000, s62
    s_mov_b32 s63, 0x00020000
    s_mul_i32 s89, s37, 1152
    s_lshl_b32 s41, s28, 7
    s_add_u32 s89, s89, s41
    s_cmp_ge_u32 s38, 36
    s_cselect_b32 s40, 1, 0
    s_cselect_b32 s41, 36, 0
    s_sub_u32 s41, s38, s41
    s_cmp_eq_u32 s40, 1
    s_cselect_b32 s48, s18, s16
    s_cselect_b32 s49, s19, s17
    s_mov_b32 s50, 0x510000
    s_mul_i32 s90, s39, 1769472
    s_lshl_b32 s41, s41, 8
    s_add_u32 s90, s90, s41
    s_add_u32 s99, s90, 128
    s_waitcnt vmcnt(20)
    s_mov_b32 m0, s88
    s_add_u32 s88, s88, 4352
    s_lshl_b32 s41, s98, 12
    s_add_u32 s41, s41, s93
    buffer_load_dwordx4 v13, s[52:55], s41 offen nt lds
    s_add_u32 m0, m0, 1088
    s_add_u32 s41, s41, s101
    buffer_load_dwordx4 v13, s[52:55], s41 offen nt lds
    s_add_u32 m0, m0, 1088
    s_add_u32 s41, s41, s101
    buffer_load_dwordx4 v13, s[52:55], s41 offen nt lds
    s_add_u32 m0, m0, 1088
    s_add_u32 s41, s41, s101
    buffer_load_dwordx4 v13, s[52:55], s41 offen nt lds
    s_add_u32 s98, s98, 1
    s_and_b32 s98, s98, 7
    s_add_u32 s92, s92, 4
    v_max_i32 v4, s92, v4
    s_waitcnt vmcnt(20)
    ds_write_b32 v3, v4 offset:0
    s_mov_b32 s91, 6
    s_cmp_eq_u32 s36, 82
    s_cbranch_scc1 L_ld_kv
    s_mov_b32 s100, 6144
    s_mov_b32 s91, 3
L_ld_gu:
    s_mov_b32 m0, s100
    s_add_u32 s100, s100, 16384
    s_mov_b32 s42, 4
L_ld_gi:
    buffer_load_dwordx4 v11, s[48:51], s90 offen nt lds
    s_add_u32 m0, m0, s101
    s_add_u32 s90, s90, 73728
    buffer_load_dwordx4 v11, s[48:51], s99 offen nt lds
    s_add_u32 m0, m0, s101
    s_add_u32 s99, s99, 73728
    buffer_load_dwordx4 v11, s[48:51], s90 offen nt lds
    s_add_u32 m0, m0, s101
    s_add_u32 s90, s90, 73728
    buffer_load_dwordx4 v11, s[48:51], s99 offen nt lds
    s_add_u32 m0, m0, s101
    s_add_u32 s99, s99, 73728
    s_add_u32 s92, s92, 4
    v_max_i32 v4, s92, v4
    s_waitcnt vmcnt(20)
    ds_write_b32 v3, v4 offset:0
    s_sub_u32 s42, s42, 1
    s_cmp_lg_u32 s42, 0
    s_cbranch_scc1 L_ld_gi
    s_mov_b32 m0, s88
    s_add_u32 s88, s88, 4352
    s_lshl_b32 s41, s98, 12
    s_add_u32 s41, s41, s93
    buffer_load_dwordx4 v13, s[52:55], s41 offen nt lds
    s_add_u32 m0, m0, 1088
    s_add_u32 s41, s41, s101
    buffer_load_dwordx4 v13, s[52:55], s41 offen nt lds
    s_add_u32 m0, m0, 1088
    s_add_u32 s41, s41, s101
    buffer_load_dwordx4 v13, s[52:55], s41 offen nt lds
    s_add_u32 m0, m0, 1088
    s_add_u32 s41, s41, s101
    buffer_load_dwordx4 v13, s[52:55], s41 offen nt lds
    s_add_u32 s98, s98, 1
    s_and_b32 s98, s98, 7
    s_add_u32 s92, s92, 4
    v_max_i32 v4, s92, v4
    s_waitcnt vmcnt(20)
    ds_write_b32 v3, v4 offset:0
    s_sub_u32 s91, s91, 1
    s_cmp_lg_u32 s91, 0
    s_cbranch_scc1 L_ld_gu
    s_mov_b32 s91, 3
L_ld_kv:
LD_2:
    s_mov_b32 m0, s88
    s_add_u32 s88, s88, 4352
    s_lshl_b32 s41, s98, 12
    s_add_u32 s41, s41, s93
    buffer_load_dwordx4 v13, s[52:55], s41 offen nt lds
    s_add_u32 m0, m0, 1088
    s_add_u32 s41, s41, s101
    buffer_load_dwordx4 v13, s[52:55], s41 offen nt lds
    s_add_u32 m0, m0, 1088
    s_add_u32 s41, s41, s101
    buffer_load_dwordx4 v13, s[52:55], s41 offen nt lds
    s_add_u32 m0, m0, 1088
    s_add_u32 s41, s41, s101
    buffer_load_dwordx4 v13, s[52:55], s41 offen nt lds
    s_add_u32 s98, s98, 1
    s_and_b32 s98, s98, 7
    s_add_u32 s92, s92, 4
    v_max_i32 v4, s92, v4
    s_waitcnt vmcnt(20)
    ds_write_b32 v3, v4 offset:0
    s_sub_u32 s91, s91, 1
    s_cmp_lg_u32 s91, 0
    s_cbranch_scc1 LD_2
L_ld_v:
    s_cmp_eq_u32 s36, 82
    s_cbranch_scc1 L_ld_tn
    s_mov_b32 s91, 7
LD_3:
    s_mov_b32 m0, s88
    s_add_u32 s88, s88, 4608
    s_lshl_b32 s41, s98, 12
    s_add_u32 s41, s41, s93
    buffer_load_dwordx4 v14, s[56:59], s41 offen nt lds
    s_add_u32 m0, m0, 1152
    s_add_u32 s41, s41, s101
    buffer_load_dwordx4 v14, s[56:59], s41 offen nt lds
    s_add_u32 m0, m0, 1152
    s_add_u32 s41, s41, s101
    buffer_load_dwordx4 v14, s[56:59], s41 offen nt lds
    s_add_u32 m0, m0, 1152
    s_add_u32 s41, s41, s101
    buffer_load_dwordx4 v14, s[56:59], s41 offen nt lds
    s_add_u32 s98, s98, 1
    s_and_b32 s98, s98, 7
    s_add_u32 s92, s92, 4
    v_max_i32 v4, s92, v4
    s_waitcnt vmcnt(20)
    ds_write_b32 v3, v4 offset:0
    s_sub_u32 s91, s91, 1
    s_cmp_lg_u32 s91, 0
    s_cbranch_scc1 LD_3
    ds_read_b32 v5, v3 offset:28
    s_mov_b32 m0, s88
    s_add_u32 s88, s88, 4608
    s_lshl_b32 s41, s98, 12
    s_add_u32 s41, s41, s93
    buffer_load_dwordx4 v14, s[56:59], s41 offen nt lds
    s_add_u32 m0, m0, 1152
    s_add_u32 s41, s41, s101
    buffer_load_dwordx4 v14, s[56:59], s41 offen nt lds
    s_add_u32 m0, m0, 1152
    s_add_u32 s41, s41, s101
    buffer_load_dwordx4 v14, s[56:59], s41 offen nt lds
    s_add_u32 m0, m0, 1152
    s_add_u32 s41, s41, s101
    buffer_load_dwordx4 v14, s[56:59], s41 offen nt lds
    s_add_u32 s98, s98, 1
    s_and_b32 s98, s98, 7
    s_add_u32 s92, s92, 4
    v_max_i32 v4, s92, v4
    s_waitcnt vmcnt(20)
    ds_write_b32 v3, v4 offset:0
    s_waitcnt lgkmcnt(0)
    v_readfirstlane_b32 s44, v5
    s_cmp_ge_i32 s44, 4
    s_cbranch_scc1 LE_5
    s_mov_b32 s45, 0
LW_4:
    ds_read_b32 v2, v3 offset:28
    s_add_u32 s45, s45, 1
    s_cmp_gt_u32 s45, 0x80000
    s_cbranch_scc1 LE_5
    s_waitcnt lgkmcnt(0)
    v_readfirstlane_b32 s44, v2
    s_cmp_lt_i32 s44, 4
    s_cbranch_scc1 LW_4
LE_5:
    s_mov_b32 s90, s89
    s_mov_b32 s91, s35
    s_mov_b32 m0, 55296
    s_mov_b32 s100, 18432
    s_add_u32 s99, s90, 9216
L_ld_s2d:
    buffer_load_dwordx4 v12, s[60:63], s90 offen nt lds
    s_add_u32 m0, m0, s101
    s_add_u32 s90, s90, s100
    buffer_load_dwordx4 v12, s[60:63], s99 offen nt lds
    s_add_u32 m0, m0, s101
    s_add_u32 s99, s99, s100
    buffer_load_dwordx4 v12, s[60:63], s90 offen nt lds
    s_add_u32 m0, m0, s101
    s_add_u32 s90, s90, s100
    buffer_load_dwordx4 v12, s[60:63], s99 offen nt lds
    s_add_u32 m0, m0, s101
    s_add_u32 s99, s99, s100
    s_add_u32 s92, s92, 4
    v_max_i32 v4, s92, v4
    s_waitcnt vmcnt(20)
    ds_write_b32 v3, v4 offset:0
    s_sub_u32 s91, s91, 1
    s_cmp_lg_u32 s91, 0
    s_cbranch_scc1 L_ld_s2d
    s_add_u32 s92, s92, 4
    v_max_i32 v4, s92, v4
    s_waitcnt vmcnt(16)
    ds_write_b32 v3, v4 offset:0
    s_branch L_ld_drain2
L_ld_tn:
    s_mov_b32 s91, 7
LD_6:
    s_mov_b32 m0, s88
    s_add_u32 s88, s88, 4608
    s_lshl_b32 s41, s98, 12
    s_add_u32 s41, s41, s93
    buffer_load_dwordx4 v14, s[56:59], s41 offen nt lds
    s_add_u32 m0, m0, 1152
    s_add_u32 s41, s41, s101
    buffer_load_dwordx4 v14, s[56:59], s41 offen nt lds
    s_add_u32 m0, m0, 1152
    s_add_u32 s41, s41, s101
    buffer_load_dwordx4 v14, s[56:59], s41 offen nt lds
    s_add_u32 m0, m0, 1152
    s_add_u32 s41, s41, s101
    buffer_load_dwordx4 v14, s[56:59], s41 offen nt lds
    s_add_u32 s98, s98, 1
    s_and_b32 s98, s98, 7
    s_add_u32 s92, s92, 4
    v_max_i32 v4, s92, v4
    s_waitcnt vmcnt(20)
    ds_write_b32 v3, v4 offset:0
    s_sub_u32 s91, s91, 1
    s_cmp_lg_u32 s91, 0
    s_cbranch_scc1 LD_6
    ds_read_b32 v5, v3 offset:28
    s_mov_b32 m0, s88
    s_add_u32 s88, s88, 4608
    s_lshl_b32 s41, s98, 12
    s_add_u32 s41, s41, s93
    buffer_load_dwordx4 v14, s[56:59], s41 offen nt lds
    s_add_u32 m0, m0, 1152
    s_add_u32 s41, s41, s101
    buffer_load_dwordx4 v14, s[56:59], s41 offen nt lds
    s_add_u32 m0, m0, 1152
    s_add_u32 s41, s41, s101
    buffer_load_dwordx4 v14, s[56:59], s41 offen nt lds
    s_add_u32 m0, m0, 1152
    s_add_u32 s41, s41, s101
    buffer_load_dwordx4 v14, s[56:59], s41 offen nt lds
    s_add_u32 s98, s98, 1
    s_and_b32 s98, s98, 7
    s_add_u32 s92, s92, 4
    v_max_i32 v4, s92, v4
    s_waitcnt vmcnt(20)
    ds_write_b32 v3, v4 offset:0
    s_waitcnt lgkmcnt(0)
    v_readfirstlane_b32 s44, v5
    s_cmp_ge_i32 s44, 4
    s_cbranch_scc1 LE_8
    s_mov_b32 s45, 0
LW_7:
    ds_read_b32 v2, v3 offset:28
    s_add_u32 s45, s45, 1
    s_cmp_gt_u32 s45, 0x80000
    s_cbranch_scc1 LE_8
    s_waitcnt lgkmcnt(0)
    v_readfirstlane_b32 s44, v2
    s_cmp_lt_i32 s44, 4
    s_cbranch_scc1 LW_7
LE_8:
    s_mov_b32 s90, s89
    s_mov_b32 s91, s35
    s_mov_b32 s40, 55296
    s_mov_b32 s41, 9216
    s_mov_b32 s100, 18432
    s_cmp_eq_u32 s28, 7
    s_cselect_b32 m0, 6144, s40
    s_cselect_b32 s100, s41, s100
    s_cselect_b32 s41, 128, s41
    s_add_u32 s99, s90, s41
    s_add_u32 s92, s92, 4
    v_max_i32 v4, s92, v4
    s_waitcnt vmcnt(16)
    ds_write_b32 v3, v4 offset:0
L_ld_s2n:
    buffer_load_dwordx4 v12, s[60:63], s90 offen nt lds
    s_add_u32 m0, m0, s101
    s_add_u32 s90, s90, s100
    buffer_load_dwordx4 v12, s[60:63], s99 offen nt lds
    s_add_u32 m0, m0, s101
    s_add_u32 s99, s99, s100
    buffer_load_dwordx4 v12, s[60:63], s90 offen nt lds
    s_add_u32 m0, m0, s101
    s_add_u32 s90, s90, s100
    buffer_load_dwordx4 v12, s[60:63], s99 offen nt lds
    s_add_u32 m0, m0, s101
    s_add_u32 s99, s99, s100
    s_add_u32 s92, s92, 4
    v_max_i32 v4, s92, v4
    s_waitcnt vmcnt(16)
    ds_write_b32 v3, v4 offset:0
    s_sub_u32 s91, s91, 1
    s_cmp_lg_u32 s91, 0
    s_cbranch_scc1 L_ld_s2n
L_ld_drain2:
    s_add_u32 s92, s92, 4
    v_max_i32 v4, s92, v4
    s_waitcnt vmcnt(12)
    ds_write_b32 v3, v4 offset:0
    s_add_u32 s92, s92, 4
    v_max_i32 v4, s92, v4
    s_waitcnt vmcnt(8)
    ds_write_b32 v3, v4 offset:0
    s_add_u32 s92, s92, 4
    v_max_i32 v4, s92, v4
    s_waitcnt vmcnt(4)
    ds_write_b32 v3, v4 offset:0
    s_add_u32 s92, s92, 4
    v_max_i32 v4, s92, v4
    s_waitcnt vmcnt(0)
    ds_write_b32 v3, v4 offset:0
    s_endpgm
L_cons3:
    s_barrier
    s_mov_b32 s64, s26
    s_mov_b32 s65, s27
    s_mov_b32 s66, 0x15c000
    s_mov_b32 s67, 0x00020000
    s_add_u32 s60, s26, 0xa0000
    s_addc_u32 s61, s27, 0
    s_mov_b32 s62, 0x97000
    s_mov_b32 s63, 0x00020000
    s_mov_b32 s47, 0
    s_mov_b32 s44, -1000
    v_lshrrev_b32 v8, 4, v0
    v_and_b32 v9, 15, v0
    v_mov_b32 v14, 0xffffff00
    s_mov_b32 s33, s29
    s_lshl_b32 s37, s29, 8
    s_sub_u32 s40, s29, 16
    s_mul_i32 s40, s40, 288
    s_cmp_lt_u32 s29, 16
    s_cselect_b32 s37, s37, s40
    s_cselect_b32 s35, 8, 9
    s_cmp_eq_u32 s28, 7
    s_cselect_b32 s40, 1, 0
    s_lshl_b32 s35, s35, s40
    s_mul_i32 s40, s28, 31
    s_add_u32 s40, s40, s29
    s_cmp_eq_u32 s29, 31
    s_cselect_b32 s40, 255, s40
    s_mul_i32 s38, s40, 171
    s_lshr_b32 s38, s38, 9
    s_mul_i32 s41, s38, 3
    s_sub_u32 s39, s40, s41
    s_mov_b32 s36, 130
    s_cmp_lt_u32 s40, 216
    s_cselect_b32 s36, s36, 82
    s_lshl2_add_u32 s34, s35, s36
    s_cmp_ge_u32 s32, 5
    s_cbranch_scc1 L_att
    s_sub_u32 s90, s32, 1
    v_lshrrev_b32 v11, 3, v0
    v_and_b32 v11, 3, v11
    v_xor_b32 v11, s90, v11
    v_lshlrev_b32 v11, 5, v11
    v_and_b32 v12, 3, v0
    v_lshl_add_u32 v11, v12, 3, v11
    v_lshrrev_b32 v10, 2, v0
    v_lshl_add_u32 v10, v10, 7, v11
    v_lshrrev_b32 v15, 5, v0
    v_lshl_add_u32 v15, v15, 10, v10
    v_add_u32 v15, 6144, v15
    v_and_b32 v12, 1, v0
    s_mov_b32 s40, 0xffff0000
    s_waitcnt vmcnt(0)
    v_lshlrev_b32 v28, 16, v16
    v_and_b32 v29, s40, v16
    v_lshlrev_b32 v30, 16, v17
    v_and_b32 v31, s40, v17
    v_lshlrev_b32 v32, 16, v18
    v_and_b32 v33, s40, v18
    v_lshlrev_b32 v34, 16, v19
    v_and_b32 v35, s40, v19
    v_lshlrev_b32 v36, 16, v20
    v_and_b32 v37, s40, v20
    v_lshlrev_b32 v38, 16, v21
    v_and_b32 v39, s40, v21
    v_lshlrev_b32 v40, 16, v22
    v_and_b32 v41, s40, v22
    v_lshlrev_b32 v42, 16, v23
    v_and_b32 v43, s40, v23
    v_lshlrev_b32 v44, 16, v24
    v_and_b32 v45, s40, v24
    v_add_f32 v4, v28, v29
    v_add_f32 v5, v30, v31
    v_add_f32 v4, v4, v32
    v_add_f32 v5, v5, v33
    v_add_f32 v4, v4, v34
    v_add_f32 v5, v5, v35
    v_add_f32 v4, v4, v36
    v_add_f32 v5, v5, v37
    v_add_f32 v4, v4, v38
    v_add_f32 v5, v5, v39
    v_add_f32 v4, v4, v40
    v_add_f32 v5, v5, v41
    v_add_f32 v4, v4, v42
    v_add_f32 v5, v5, v43
    v_add_f32 v4, v4, v44
    v_add_f32 v5, v5, v45
    v_add_f32 v4, v4, v5
    s_nop 1
    v_add_f32_dpp v4, v4, v4 quad_perm:[1,0,3,2] row_mask:0xf bank_mask:0xf
    s_nop 1
    v_add_f32_dpp v4, v4, v4 quad_perm:[2,3,0,1] row_mask:0xf bank_mask:0xf
    s_nop 1
    v_add_f32_dpp v4, v4, v4 row_ror:4 row_mask:0xf bank_mask:0xf
    s_nop 1
    v_add_f32_dpp v4, v4, v4 row_ror:8 row_mask:0xf bank_mask:0xf
    v_mov_b32 v5, v4
    s_nop 1
    v_permlane16_swap_b32 v4, v5
    v_add_f32 v4, v4, v5
    v_mul_f32 v4, 0x3ae38e39, v4
    v_mov_b32 v5, 0
    v_mov_b32 v25, 0
    v_sub_f32 v26, v28, v4
    v_sub_f32 v27, v29, v4
    v_fmac_f32 v5, v26, v26
    v_fmac_f32 v25, v27, v27
    v_sub_f32 v26, v30, v4
    v_sub_f32 v27, v31, v4
    v_fmac_f32 v5, v26, v26
    v_fmac_f32 v25, v27, v27
    v_sub_f32 v26, v32, v4
    v_sub_f32 v27, v33, v4
    v_fmac_f32 v5, v26, v26
    v_fmac_f32 v25, v27, v27
    v_sub_f32 v26, v34, v4
    v_sub_f32 v27, v35, v4
    v_fmac_f32 v5, v26, v26
    v_fmac_f32 v25, v27, v27
    v_sub_f32 v26, v36, v4
    v_sub_f32 v27, v37, v4
    v_fmac_f32 v5, v26, v26
    v_fmac_f32 v25, v27, v27
    v_sub_f32 v26, v38, v4
    v_sub_f32 v27, v39, v4
    v_fmac_f32 v5, v26, v26
    v_fmac_f32 v25, v27, v27
    v_sub_f32 v26, v40, v4
    v_sub_f32 v27, v41, v4
    v_fmac_f32 v5, v26, v26
    v_fmac_f32 v25, v27, v27
    v_sub_f32 v26, v42, v4
    v_sub_f32 v27, v43, v4
    v_fmac_f32 v5, v26, v26
    v_fmac_f32 v25, v27, v27
    v_sub_f32 v26, v44, v4
    v_sub_f32 v27, v45, v4
    v_fmac_f32 v5, v26, v26
    v_fmac_f32 v25, v27, v27
    v_add_f32 v5, v5, v25
    s_nop 1
    v_add_f32_dpp v5, v5, v5 quad_perm:[1,0,3,2] row_mask:0xf bank_mask:0xf
    s_nop 1
    v_add_f32_dpp v5, v5, v5 quad_perm:[2,3,0,1] row_mask:0xf bank_mask:0xf
    s_nop 1
    v_add_f32_dpp v5, v5, v5 row_ror:4 row_mask:0xf bank_mask:0xf
    s_nop 1
    v_add_f32_dpp v5, v5, v5 row_ror:8 row_mask:0xf bank_mask:0xf
    v_mov_b32 v25, v5
    s_nop 1
    v_permlane16_swap_b32 v5, v25
    v_add_f32 v5, v5, v25
    v_mul_f32 v5, 0x3ae38e39, v5
    v_cvt_pk_bf16_f32 v4, v4, v5
    v_and_b32 v5, s40, v4
    v_lshlrev_b32 v4, 16, v4
    v_add_f32 v5, 0x3727c5ac, v5
    v_cvt_pk_bf16_f32 v5, v5, v5
    v_lshlrev_b32 v5, 16, v5
    v_sqrt_f32 v5, v5
    s_nop 0
    v_cvt_pk_bf16_f32 v5, v5, v5
    v_lshlrev_b32 v5, 16, v5
    v_rcp_f32 v5, v5
    v_sub_f32 v26, v28, v4
    v_sub_f32 v27, v29, v4
    v_cvt_pk_bf16_f32 v26, v26, v27
    v_and_b32 v27, s40, v26
    v_lshlrev_b32 v26, 16, v26
    v_mul_f32 v26, v26, v5
    v_mul_f32 v27, v27, v5
    v_cvt_pk_bf16_f32 v16, v26, v27
    v_sub_f32 v26, v30, v4
    v_sub_f32 v27, v31, v4
    v_cvt_pk_bf16_f32 v26, v26, v27
    v_and_b32 v27, s40, v26
    v_lshlrev_b32 v26, 16, v26
    v_mul_f32 v26, v26, v5
    v_mul_f32 v27, v27, v5
    v_cvt_pk_bf16_f32 v17, v26, v27
    v_sub_f32 v26, v32, v4
    v_sub_f32 v27, v33, v4
    v_cvt_pk_bf16_f32 v26, v26, v27
    v_and_b32 v27, s40, v26
    v_lshlrev_b32 v26, 16, v26
    v_mul_f32 v26, v26, v5
    v_mul_f32 v27, v27, v5
    v_cvt_pk_bf16_f32 v18, v26, v27
    v_sub_f32 v26, v34, v4
    v_sub_f32 v27, v35, v4
    v_cvt_pk_bf16_f32 v26, v26, v27
    v_and_b32 v27, s40, v26
    v_lshlrev_b32 v26, 16, v26
    v_mul_f32 v26, v26, v5
    v_mul_f32 v27, v27, v5
    v_cvt_pk_bf16_f32 v19, v26, v27
    v_sub_f32 v26, v36, v4
    v_sub_f32 v27, v37, v4
    v_cvt_pk_bf16_f32 v26, v26, v27
    v_and_b32 v27, s40, v26
    v_lshlrev_b32 v26, 16, v26
    v_mul_f32 v26, v26, v5
    v_mul_f32 v27, v27, v5
    v_cvt_pk_bf16_f32 v20, v26, v27
    v_sub_f32 v26, v38, v4
    v_sub_f32 v27, v39, v4
    v_cvt_pk_bf16_f32 v26, v26, v27
    v_and_b32 v27, s40, v26
    v_lshlrev_b32 v26, 16, v26
    v_mul_f32 v26, v26, v5
    v_mul_f32 v27, v27, v5
    v_cvt_pk_bf16_f32 v21, v26, v27
    v_sub_f32 v26, v40, v4
    v_sub_f32 v27, v41, v4
    v_cvt_pk_bf16_f32 v26, v26, v27
    v_and_b32 v27, s40, v26
    v_lshlrev_b32 v26, 16, v26
    v_mul_f32 v26, v26, v5
    v_mul_f32 v27, v27, v5
    v_cvt_pk_bf16_f32 v22, v26, v27
    v_sub_f32 v26, v42, v4
    v_sub_f32 v27, v43, v4
    v_cvt_pk_bf16_f32 v26, v26, v27
    v_and_b32 v27, s40, v26
    v_lshlrev_b32 v26, 16, v26
    v_mul_f32 v26, v26, v5
    v_mul_f32 v27, v27, v5
    v_cvt_pk_bf16_f32 v23, v26, v27
    v_sub_f32 v26, v44, v4
    v_sub_f32 v27, v45, v4
    v_cvt_pk_bf16_f32 v26, v26, v27
    v_and_b32 v27, s40, v26
    v_lshlrev_b32 v26, 16, v26
    v_mul_f32 v26, v26, v5
    v_mul_f32 v27, v27, v5
    v_cvt_pk_bf16_f32 v24, v26, v27
    ds_write2_b32 v13, v16, v17 offset0:64 offset1:65
    ds_write2_b32 v13, v18, v19 offset0:66 offset1:67
    ds_write2_b32 v13, v20, v21 offset0:68 offset1:69
    ds_write2_b32 v13, v22, v23 offset0:70 offset1:71
    ds_write_b32 v13, v24 offset:288
    v_mul_u32_u24 v11, 1152, v12
    v_lshl_add_u32 v11, v8, 3, v11
    v_add_u32 v11, 256, v11
    s_and_b32 s40, s29, 3
    s_mul_i32 s40, s40, 288
    v_add_u32 v13, s40, v11
    ds_read2_b64 v[40:43], v13 offset0:0 offset1:4
    ds_read2_b64 v[44:47], v13 offset0:8 offset1:12
    ds_read2_b64 v[48:51], v13 offset0:16 offset1:20
    ds_read2_b64 v[52:55], v13 offset0:24 offset1:28
    ds_read_b64 v[56:57], v13 offset:256
    v_mov_b32 v60, 0
    v_mov_b32 v61, 0
    v_mov_b32 v62, 0
    v_mov_b32 v63, 0
    v_mov_b32 v64, 0
    v_mov_b32 v65, 0
    v_mov_b32 v66, 0
    v_mov_b32 v67, 0
    v_add_u32 v13, 55296, v10
    s_waitcnt lgkmcnt(0)
    s_mul_i32 s46, s46, 1664525
    s_add_u32 s46, s46, 1013904223
    s_and_b32 s94, s46, 0xff
    s_bfe_u32 s95, s46, 0x80008
    s_bfe_u32 s96, s46, 0x80010
    s_lshr_b32 s97, s46, 24
    v_lshlrev_b32 v1, 6, v9
    v_lshl_add_u32 v1, v8, 4, v1
    s_lshr_b32 s40, s29, 2
    s_xor_b32 s40, s40, 4
    s_lshr_b32 s41, s40, 2
    s_lshl1_add_u32 s41, s28, s41
    s_and_b32 s42, s29, 3
    s_lshl2_add_u32 s41, s41, s42
    s_and_b32 s40, s40, 3
    s_lshl2_add_u32 s41, s41, s40
    s_lshl2_add_u32 s41, s41, s90
    s_lshl_b32 s41, s41, 7
    s_add_u32 s93, s41, 4096
    v_cmp_gt_u32 vcc, 2, v9
    s_mov_b64 s[68:69], vcc
    s_cmp_ge_i32 s44, 18
    s_cbranch_scc1 LE_10
    s_mov_b32 s45, 0
LW_9:
    ds_read_b32 v2, v3 offset:0
    s_add_u32 s45, s45, 1
    s_cmp_gt_u32 s45, 0x80000
    s_cbranch_scc1 LE_10
    s_waitcnt lgkmcnt(0)
    v_readfirstlane_b32 s44, v2
    s_cmp_lt_i32 s44, 18
    s_cbranch_scc1 LW_9
LE_10:
    ds_read_b64_tr_b16 v[16:17], v13 offset:0
    ds_read_b64_tr_b16 v[18:19], v13 offset:2048
    ds_read_b64_tr_b16 v[20:21], v13 offset:4096
    ds_read_b64_tr_b16 v[22:23], v13 offset:6144
    ds_read_b64_tr_b16 v[24:25], v13 offset:8192
    ds_read_b64_tr_b16 v[26:27], v13 offset:10240
    ds_read_b64_tr_b16 v[28:29], v13 offset:12288
    ds_read_b64_tr_b16 v[30:31], v13 offset:14336
    ds_read_b64_tr_b16 v[32:33], v13 offset:16384
    s_waitcnt lgkmcnt(7)
    v_mfma_f32_16x16x32_bf16 v[60:63], v[16:19], v[40:43], v[60:63]
    s_waitcnt lgkmcnt(5)
    v_mfma_f32_16x16x32_bf16 v[60:63], v[20:23], v[44:47], v[60:63]
    s_waitcnt lgkmcnt(3)
    v_mfma_f32_16x16x32_bf16 v[60:63], v[24:27], v[48:51], v[60:63]
    s_waitcnt lgkmcnt(1)
    v_mfma_f32_16x16x32_bf16 v[60:63], v[28:31], v[52:55], v[60:63]
    s_waitcnt lgkmcnt(0)
    v_mfma_f32_16x16x16_bf16 v[64:67], v[32:33], v[56:57], v[64:67]
    s_mov_b64 exec, 1
    v_mov_b32 v6, 1
    ds_add_u32 v3, v6 offset:28
    s_mov_b64 exec, -1
    s_nop 4
    v_add_f32 v72, v60, v64
    v_add_f32 v73, v61, v65
    v_add_f32 v74, v62, v66
    v_add_f32 v75, v63, v67
    v_add_u32 v72, 0x80, v72
    v_add_u32 v73, 0x80, v73
    v_add_u32 v74, 0x80, v74
    v_add_u32 v75, 0x80, v75
    v_and_or_b32 v72, v72, v14, s94
    v_and_or_b32 v73, v73, v14, s95
    v_and_or_b32 v74, v74, v14, s96
    v_and_or_b32 v75, v75, v14, s97
    s_mov_b64 exec, s[68:69]
    buffer_store_dwordx4 v[72:75], v1, s[64:67], s93 offen
    s_mov_b64 exec, -1
    s_mov_b32 s99, s93
    s_cmp_lg_u32 s36, 82
    s_cbranch_scc1 LH_11
    s_cmp_ge_i32 s47, 1
    s_cbranch_scc1 LE_13
    s_mov_b32 s45, 0
LW_12:
    ds_read_b32 v2, v3 offset:32
    s_add_u32 s45, s45, 1
    s_cmp_gt_u32 s45, 0x80000
    s_cbranch_scc1 LE_13
    s_waitcnt lgkmcnt(0)
    v_readfirstlane_b32 s47, v2
    s_cmp_lt_i32 s47, 1
    s_cbranch_scc1 LW_12
LE_13:
    s_cmp_lg_u32 s47, 1
    s_cbranch_scc1 LS_14
LB_15:
    s_branch L_w_s2
LH_11:
    s_mul_i32 s40, s39, 384
    v_add_u32 v13, s40, v11
    ds_read2_b64 v[40:43], v13 offset0:0 offset1:4
    ds_read2_b64 v[44:47], v13 offset0:8 offset1:12
    ds_read2_b64 v[48:51], v13 offset0:16 offset1:20
    ds_read2_b64 v[52:55], v13 offset0:24 offset1:28
    ds_read2_b64 v[56:59], v13 offset0:32 offset1:36
    ds_read2_b64 v[60:63], v13 offset0:40 offset1:44
    v_mov_b32 v64, 0
    v_mov_b32 v65, 0
    v_mov_b32 v66, 0
    v_mov_b32 v67, 0
    v_mov_b32 v68, 0
    v_mov_b32 v69, 0
    v_mov_b32 v70, 0
    v_mov_b32 v71, 0
    s_cmp_ge_u32 s38, 36
    s_cselect_b32 s40, 1, 0
    s_cselect_b32 s41, 36, 0
    s_sub_u32 s41, s38, s41
    s_mul_i32 s40, s40, 3
    s_add_u32 s40, s40, s39
    s_mul_i32 s40, s40, 36864
    s_lshl3_add_u32 s41, s41, s90
    s_lshl_b32 s41, s41, 7
    s_add_u32 s40, s40, s41
    s_add_u32 s93, s40, 135168
    s_cmp_ge_i32 s44, 34
    s_cbranch_scc1 LE_17
    s_mov_b32 s45, 0
LW_16:
    ds_read_b32 v2, v3 offset:0
    s_add_u32 s45, s45, 1
    s_cmp_gt_u32 s45, 0x80000
    s_cbranch_scc1 LE_17
    s_waitcnt lgkmcnt(0)
    v_readfirstlane_b32 s44, v2
    s_cmp_lt_i32 s44, 34
    s_cbranch_scc1 LW_16
LE_17:
    ds_read_b64_tr_b16 v[16:17], v15 offset:0
    ds_read_b64_tr_b16 v[18:19], v15 offset:4096
    ds_read_b64_tr_b16 v[20:21], v15 offset:1024
    ds_read_b64_tr_b16 v[22:23], v15 offset:5120
    s_waitcnt lgkmcnt(2)
    v_mfma_f32_16x16x32_bf16 v[64:67], v[16:19], v[40:43], v[64:67]
    s_waitcnt lgkmcnt(0)
    v_mfma_f32_16x16x32_bf16 v[68:71], v[20:23], v[40:43], v[68:71]
    s_cmp_ge_i32 s44, 42
    s_cbranch_scc1 LE_19
    s_mov_b32 s45, 0
LW_18:
    ds_read_b32 v2, v3 offset:0
    s_add_u32 s45, s45, 1
    s_cmp_gt_u32 s45, 0x80000
    s_cbranch_scc1 LE_19
    s_waitcnt lgkmcnt(0)
    v_readfirstlane_b32 s44, v2
    s_cmp_lt_i32 s44, 42
    s_cbranch_scc1 LW_18
LE_19:
    ds_read_b64_tr_b16 v[16:17], v15 offset:8192
    ds_read_b64_tr_b16 v[18:19], v15 offset:12288
    ds_read_b64_tr_b16 v[20:21], v15 offset:9216
    ds_read_b64_tr_b16 v[22:23], v15 offset:13312
    s_waitcnt lgkmcnt(2)
    v_mfma_f32_16x16x32_bf16 v[64:67], v[16:19], v[44:47], v[64:67]
    s_waitcnt lgkmcnt(0)
    v_mfma_f32_16x16x32_bf16 v[68:71], v[20:23], v[44:47], v[68:71]
    s_cmp_ge_i32 s44, 54
    s_cbranch_scc1 LE_21
    s_mov_b32 s45, 0
LW_20:
    ds_read_b32 v2, v3 offset:0
    s_add_u32 s45, s45, 1
    s_cmp_gt_u32 s45, 0x80000
    s_cbranch_scc1 LE_21
    s_waitcnt lgkmcnt(0)
    v_readfirstlane_b32 s44, v2
    s_cmp_lt_i32 s44, 54
    s_cbranch_scc1 LW_20
LE_21:
    ds_read_b64_tr_b16 v[16:17], v15 offset:16384
    ds_read_b64_tr_b16 v[18:19], v15 offset:20480
    ds_read_b64_tr_b16 v[20:21], v15 offset:17408
    ds_read_b64_tr_b16 v[22:23], v15 offset:21504
    s_waitcnt lgkmcnt(2)
    v_mfma_f32_16x16x32_bf16 v[64:67], v[16:19], v[48:51], v[64:67]
    s_waitcnt lgkmcnt(0)
    v_mfma_f32_16x16x32_bf16 v[68:71], v[20:23], v[48:51], v[68:71]
    s_cmp_ge_i32 s44, 62
    s_cbranch_scc1 LE_23
    s_mov_b32 s45, 0
LW_22:
    ds_read_b32 v2, v3 offset:0
    s_add_u32 s45, s45, 1
    s_cmp_gt_u32 s45, 0x80000
    s_cbranch_scc1 LE_23
    s_waitcnt lgkmcnt(0)
    v_readfirstlane_b32 s44, v2
    s_cmp_lt_i32 s44, 62
    s_cbranch_scc1 LW_22
LE_23:
    ds_read_b64_tr_b16 v[16:17], v15 offset:24576
    ds_read_b64_tr_b16 v[18:19], v15 offset:28672
    ds_read_b64_tr_b16 v[20:21], v15 offset:25600
    ds_read_b64_tr_b16 v[22:23], v15 offset:29696
    s_waitcnt lgkmcnt(2)
    v_mfma_f32_16x16x32_bf16 v[64:67], v[16:19], v[52:55], v[64:67]
    s_waitcnt lgkmcnt(0)
    v_mfma_f32_16x16x32_bf16 v[68:71], v[20:23], v[52:55], v[68:71]
    s_cmp_ge_i32 s44, 74
    s_cbranch_scc1 LE_25
    s_mov_b32 s45, 0
LW_24:
    ds_read_b32 v2, v3 offset:0
    s_add_u32 s45, s45, 1
    s_cmp_gt_u32 s45, 0x80000
    s_cbranch_scc1 LE_25
    s_waitcnt lgkmcnt(0)
    v_readfirstlane_b32 s44, v2
    s_cmp_lt_i32 s44, 74
    s_cbranch_scc1 LW_24
LE_25:
    ds_read_b64_tr_b16 v[16:17], v15 offset:32768
    ds_read_b64_tr_b16 v[18:19], v15 offset:36864
    ds_read_b64_tr_b16 v[20:21], v15 offset:33792
    ds_read_b64_tr_b16 v[22:23], v15 offset:37888
    s_waitcnt lgkmcnt(2)
    v_mfma_f32_16x16x32_bf16 v[64:67], v[16:19], v[56:59], v[64:67]
    s_waitcnt lgkmcnt(0)
    v_mfma_f32_16x16x32_bf16 v[68:71], v[20:23], v[56:59], v[68:71]
    s_cmp_ge_i32 s47, 1
    s_cbranch_scc1 LE_27
    s_mov_b32 s45, 0
LW_26:
    ds_read_b32 v2, v3 offset:32
    s_add_u32 s45, s45, 1
    s_cmp_gt_u32 s45, 0x80000
    s_cbranch_scc1 LE_27
    s_waitcnt lgkmcnt(0)
    v_readfirstlane_b32 s47, v2
    s_cmp_lt_i32 s47, 1
    s_cbranch_scc1 LW_26
LE_27:
    s_cmp_lg_u32 s47, 1
    s_cbranch_scc1 LS_28
LB_29:
    s_cmp_ge_i32 s44, 82
    s_cbranch_scc1 LE_31
    s_mov_b32 s45, 0
LW_30:
    ds_read_b32 v2, v3 offset:0
    s_add_u32 s45, s45, 1
    s_cmp_gt_u32 s45, 0x80000
    s_cbranch_scc1 LE_31
    s_waitcnt lgkmcnt(0)
    v_readfirstlane_b32 s44, v2
    s_cmp_lt_i32 s44, 82
    s_cbranch_scc1 LW_30
LE_31:
    ds_read_b64_tr_b16 v[16:17], v15 offset:40960
    ds_read_b64_tr_b16 v[18:19], v15 offset:45056
    ds_read_b64_tr_b16 v[20:21], v15 offset:41984
    ds_read_b64_tr_b16 v[22:23], v15 offset:46080
    s_waitcnt lgkmcnt(2)
    v_mfma_f32_16x16x32_bf16 v[64:67], v[16:19], v[60:63], v[64:67]
    s_waitcnt lgkmcnt(0)
    v_mfma_f32_16x16x32_bf16 v[68:71], v[20:23], v[60:63], v[68:71]
    s_nop 5
    v_add_u32 v64, 0x80, v64
    v_add_u32 v65, 0x80, v65
    v_add_u32 v66, 0x80, v66
    v_add_u32 v67, 0x80, v67
    v_and_or_b32 v64, v64, v14, s94
    v_and_or_b32 v65, v65, v14, s95
    v_and_or_b32 v66, v66, v14, s96
    v_and_or_b32 v67, v67, v14, s97
    v_add_u32 v68, 0x80, v68
    v_add_u32 v69, 0x80, v69
    v_add_u32 v70, 0x80, v70
    v_add_u32 v71, 0x80, v71
    v_and_or_b32 v68, v68, v14, s94
    v_and_or_b32 v69, v69, v14, s95
    v_and_or_b32 v70, v70, v14, s96
    v_and_or_b32 v71, v71, v14, s97
    s_mov_b64 exec, s[68:69]
    buffer_store_dwordx4 v[64:67], v1, s[60:63], s93 offen sc1
    buffer_store_dwordx4 v[68:71], v1, s[60:63], s93 offen offset:512 sc1
    s_mov_b64 exec, -1
L_w_s2:
    v_mul_u32_u24 v11, 704, v12
    v_lshl_add_u32 v11, v8, 4, v11
    v_mov_b32 v80, 0
    v_mov_b32 v81, 0
    v_mov_b32 v82, 0
    v_mov_b32 v83, 0
    v_mov_b32 v84, 0
    v_mov_b32 v85, 0
    v_mov_b32 v86, 0
    v_mov_b32 v87, 0
    v_add_u32 v10, 55296, v10
    v_add_u32 v13, 0x10000, v15
    s_mov_b32 s42, s33
    s_lshl2_add_u32 s40, s28, s90
    s_lshl_b32 s40, s40, 12
    s_lshl_b32 s41, s42, 7
    s_add_u32 s40, s40, s41
    s_add_u32 s93, s40, 1273856
    s_add_u32 s98, s93, 16384
    s_cmp_ge_u32 s33, 16
    s_cbranch_scc1 L_w_dn
    s_cmp_eq_u32 s28, 7
    s_cbranch_scc1 L_wo2
    s_cmp_ge_i32 s44, 138
    s_cbranch_scc1 LE_33
    s_mov_b32 s45, 0
LW_32:
    ds_read_b32 v2, v3 offset:0
    s_add_u32 s45, s45, 1
    s_cmp_gt_u32 s45, 0x80000
    s_cbranch_scc1 LE_33
    s_waitcnt lgkmcnt(0)
    v_readfirstlane_b32 s44, v2
    s_cmp_lt_i32 s44, 138
    s_cbranch_scc1 LW_32
LE_33:
    ds_read_b64_tr_b16 v[88:89], v10 offset:0
    ds_read_b64_tr_b16 v[90:91], v10 offset:2048
    ds_read_b64_tr_b16 v[92:93], v10 offset:4096
    ds_read_b64_tr_b16 v[94:95], v10 offset:6144
    s_cmp_ge_i32 s44, 146
    s_cbranch_scc1 LE_35
    s_mov_b32 s45, 0
LW_34:
    ds_read_b32 v2, v3 offset:0
    s_add_u32 s45, s45, 1
    s_cmp_gt_u32 s45, 0x80000
    s_cbranch_scc1 LE_35
    s_waitcnt lgkmcnt(0)
    v_readfirstlane_b32 s44, v2
    s_cmp_lt_i32 s44, 146
    s_cbranch_scc1 LW_34
LE_35:
    ds_read_b64_tr_b16 v[96:97], v10 offset:8192
    ds_read_b64_tr_b16 v[98:99], v10 offset:10240
    ds_read_b64_tr_b16 v[100:101], v10 offset:12288
    ds_read_b64_tr_b16 v[102:103], v10 offset:14336
    s_cmp_ge_i32 s44, 154
    s_cbranch_scc1 LE_37
    s_mov_b32 s45, 0
LW_36:
    ds_read_b32 v2, v3 offset:0
    s_add_u32 s45, s45, 1
    s_cmp_gt_u32 s45, 0x80000
    s_cbranch_scc1 LE_37
    s_waitcnt lgkmcnt(0)
    v_readfirstlane_b32 s44, v2
    s_cmp_lt_i32 s44, 154
    s_cbranch_scc1 LW_36
LE_37:
    ds_read_b64_tr_b16 v[104:105], v10 offset:16384
    ds_read_b64_tr_b16 v[106:107], v10 offset:18432
    ds_read_b64_tr_b16 v[108:109], v10 offset:20480
    ds_read_b64_tr_b16 v[110:111], v10 offset:22528
    s_cmp_ge_i32 s44, 162
    s_cbranch_scc1 LE_39
    s_mov_b32 s45, 0
LW_38:
    ds_read_b32 v2, v3 offset:0
    s_add_u32 s45, s45, 1
    s_cmp_gt_u32 s45, 0x80000
    s_cbranch_scc1 LE_39
    s_waitcnt lgkmcnt(0)
    v_readfirstlane_b32 s44, v2
    s_cmp_lt_i32 s44, 162
    s_cbranch_scc1 LW_38
LE_39:
    ds_read_b64_tr_b16 v[112:113], v10 offset:24576
    ds_read_b64_tr_b16 v[114:115], v10 offset:26624
    ds_read_b64_tr_b16 v[116:117], v10 offset:28672
    ds_read_b64_tr_b16 v[118:119], v10 offset:30720
    s_barrier
    ds_read_b128 v[16:19], v11 offset:3072
    ds_read_b128 v[20:23], v11 offset:3136
    ds_read_b128 v[24:27], v11 offset:3200
    ds_read_b128 v[28:31], v11 offset:3264
    ds_read_b128 v[32:35], v11 offset:3328
    ds_read_b128 v[36:39], v11 offset:3392
    ds_read_b128 v[40:43], v11 offset:3456
    ds_read_b128 v[44:47], v11 offset:3520
    s_waitcnt lgkmcnt(7)
    v_mfma_f32_16x16x32_bf16 v[80:83], v[88:91], v[16:19], v[80:83]
    s_waitcnt lgkmcnt(6)
    v_mfma_f32_16x16x32_bf16 v[80:83], v[92:95], v[20:23], v[80:83]
    s_waitcnt lgkmcnt(5)
    v_mfma_f32_16x16x32_bf16 v[80:83], v[96:99], v[24:27], v[80:83]
    s_waitcnt lgkmcnt(4)
    v_mfma_f32_16x16x32_bf16 v[80:83], v[100:103], v[28:31], v[80:83]
    s_waitcnt lgkmcnt(3)
    v_mfma_f32_16x16x32_bf16 v[80:83], v[104:107], v[32:35], v[80:83]
    s_waitcnt lgkmcnt(2)
    v_mfma_f32_16x16x32_bf16 v[80:83], v[108:111], v[36:39], v[80:83]
    s_waitcnt lgkmcnt(1)
    v_mfma_f32_16x16x32_bf16 v[80:83], v[112:115], v[40:43], v[80:83]
    s_waitcnt lgkmcnt(0)
    v_mfma_f32_16x16x32_bf16 v[80:83], v[116:119], v[44:47], v[80:83]
L_s2_pub:
    s_mov_b64 exec, s[68:69]
    s_nop 6
    v_and_or_b32 v80, v80, v14, s94
    v_and_or_b32 v81, v81, v14, s95
    v_and_or_b32 v82, v82, v14, s96
    v_and_or_b32 v83, v83, v14, s97
    s_cmp_lg_u32 s47, 1
    s_cbranch_scc1 LS_40
    buffer_store_dwordx4 v[80:83], v1, s[64:67], s93 offen
LB_41:
L_w_end:
    s_endpgm
LS_14:
    s_mov_b64 exec, s[68:69]
    buffer_store_dwordx4 v[72:75], v1, s[60:63], s99 offen sc1
    s_mov_b64 exec, -1
    s_branch LB_15
LS_28:
    s_mov_b64 exec, s[68:69]
    buffer_store_dwordx4 v[72:75], v1, s[60:63], s99 offen sc1
    s_mov_b64 exec, -1
    s_branch LB_29
LS_40:
    buffer_store_dwordx4 v[80:83], v1, s[64:67], s93 offen sc1
    s_branch LB_41
L_wo2:
    s_cmp_ge_i32 s44, 90
    s_cbranch_scc1 LE_43
    s_mov_b32 s45, 0
LW_42:
    ds_read_b32 v2, v3 offset:0
    s_add_u32 s45, s45, 1
    s_cmp_gt_u32 s45, 0x80000
    s_cbranch_scc1 LE_43
    s_waitcnt lgkmcnt(0)
    v_readfirstlane_b32 s44, v2
    s_cmp_lt_i32 s44, 90
    s_cbranch_scc1 LW_42
LE_43:
    ds_read_b64_tr_b16 v[88:89], v15 offset:0
    ds_read_b64_tr_b16 v[90:91], v15 offset:4096
    ds_read_b64_tr_b16 v[92:93], v15 offset:1024
    ds_read_b64_tr_b16 v[94:95], v15 offset:5120
    s_cmp_ge_i32 s44, 98
    s_cbranch_scc1 LE_45
    s_mov_b32 s45, 0
LW_44:
    ds_read_b32 v2, v3 offset:0
    s_add_u32 s45, s45, 1
    s_cmp_gt_u32 s45, 0x80000
    s_cbranch_scc1 LE_45
    s_waitcnt lgkmcnt(0)
    v_readfirstlane_b32 s44, v2
    s_cmp_lt_i32 s44, 98
    s_cbranch_scc1 LW_44
LE_45:
    ds_read_b64_tr_b16 v[96:97], v15 offset:8192
    ds_read_b64_tr_b16 v[98:99], v15 offset:12288
    ds_read_b64_tr_b16 v[100:101], v15 offset:9216
    ds_read_b64_tr_b16 v[102:103], v15 offset:13312
    s_cmp_ge_i32 s44, 106
    s_cbranch_scc1 LE_47
    s_mov_b32 s45, 0
LW_46:
    ds_read_b32 v2, v3 offset:0
    s_add_u32 s45, s45, 1
    s_cmp_gt_u32 s45, 0x80000
    s_cbranch_scc1 LE_47
    s_waitcnt lgkmcnt(0)
    v_readfirstlane_b32 s44, v2
    s_cmp_lt_i32 s44, 106
    s_cbranch_scc1 LW_46
LE_47:
    ds_read_b64_tr_b16 v[104:105], v15 offset:16384
    ds_read_b64_tr_b16 v[106:107], v15 offset:20480
    ds_read_b64_tr_b16 v[108:109], v15 offset:17408
    ds_read_b64_tr_b16 v[110:111], v15 offset:21504
    s_cmp_ge_i32 s44, 114
    s_cbranch_scc1 LE_49
    s_mov_b32 s45, 0
LW_48:
    ds_read_b32 v2, v3 offset:0
    s_add_u32 s45, s45, 1
    s_cmp_gt_u32 s45, 0x80000
    s_cbranch_scc1 LE_49
    s_waitcnt lgkmcnt(0)
    v_readfirstlane_b32 s44, v2
    s_cmp_lt_i32 s44, 114
    s_cbranch_scc1 LW_48
LE_49:
    ds_read_b64_tr_b16 v[112:113], v15 offset:24576
    ds_read_b64_tr_b16 v[114:115], v15 offset:28672
    ds_read_b64_tr_b16 v[116:117], v15 offset:25600
    ds_read_b64_tr_b16 v[118:119], v15 offset:29696
    s_cmp_ge_i32 s44, 122
    s_cbranch_scc1 LE_51
    s_mov_b32 s45, 0
LW_50:
    ds_read_b32 v2, v3 offset:0
    s_add_u32 s45, s45, 1
    s_cmp_gt_u32 s45, 0x80000
    s_cbranch_scc1 LE_51
    s_waitcnt lgkmcnt(0)
    v_readfirstlane_b32 s44, v2
    s_cmp_lt_i32 s44, 122
    s_cbranch_scc1 LW_50
LE_51:
    ds_read_b64_tr_b16 v[120:121], v15 offset:32768
    ds_read_b64_tr_b16 v[122:123], v15 offset:36864
    ds_read_b64_tr_b16 v[124:125], v15 offset:33792
    ds_read_b64_tr_b16 v[126:127], v15 offset:37888
    s_cmp_ge_i32 s44, 130
    s_cbranch_scc1 LE_53
    s_mov_b32 s45, 0
LW_52:
    ds_read_b32 v2, v3 offset:0
    s_add_u32 s45, s45, 1
    s_cmp_gt_u32 s45, 0x80000
    s_cbranch_scc1 LE_53
    s_waitcnt lgkmcnt(0)
    v_readfirstlane_b32 s44, v2
    s_cmp_lt_i32 s44, 130
    s_cbranch_scc1 LW_52
LE_53:
    ds_read_b64_tr_b16 v[128:129], v15 offset:40960
    ds_read_b64_tr_b16 v[130:131], v15 offset:45056
    ds_read_b64_tr_b16 v[132:133], v15 offset:41984
    ds_read_b64_tr_b16 v[134:135], v15 offset:46080
    s_cmp_ge_i32 s44, 138
    s_cbranch_scc1 LE_55
    s_mov_b32 s45, 0
LW_54:
    ds_read_b32 v2, v3 offset:0
    s_add_u32 s45, s45, 1
    s_cmp_gt_u32 s45, 0x80000
    s_cbranch_scc1 LE_55
    s_waitcnt lgkmcnt(0)
    v_readfirstlane_b32 s44, v2
    s_cmp_lt_i32 s44, 138
    s_cbranch_scc1 LW_54
LE_55:
    ds_read_b64_tr_b16 v[136:137], v15 offset:49152
    ds_read_b64_tr_b16 v[138:139], v15 offset:53248
    ds_read_b64_tr_b16 v[140:141], v15 offset:50176
    ds_read_b64_tr_b16 v[142:143], v15 offset:54272
    s_cmp_ge_i32 s44, 146
    s_cbranch_scc1 LE_57
    s_mov_b32 s45, 0
LW_56:
    ds_read_b32 v2, v3 offset:0
    s_add_u32 s45, s45, 1
    s_cmp_gt_u32 s45, 0x80000
    s_cbranch_scc1 LE_57
    s_waitcnt lgkmcnt(0)
    v_readfirstlane_b32 s44, v2
    s_cmp_lt_i32 s44, 146
    s_cbranch_scc1 LW_56
LE_57:
    ds_read_b64_tr_b16 v[144:145], v15 offset:57344
    ds_read_b64_tr_b16 v[146:147], v15 offset:61440
    ds_read_b64_tr_b16 v[148:149], v15 offset:58368
    ds_read_b64_tr_b16 v[150:151], v15 offset:62464
    s_barrier
    ds_read_b128 v[16:19], v11 offset:3072
    ds_read_b128 v[20:23], v11 offset:3136
    ds_read_b128 v[24:27], v11 offset:3200
    ds_read_b128 v[28:31], v11 offset:3264
    ds_read_b128 v[32:35], v11 offset:3328
    ds_read_b128 v[36:39], v11 offset:3392
    ds_read_b128 v[40:43], v11 offset:3456
    ds_read_b128 v[44:47], v11 offset:3520
    s_waitcnt lgkmcnt(7)
    v_mfma_f32_16x16x32_bf16 v[80:83], v[88:91], v[16:19], v[80:83]
    v_mfma_f32_16x16x32_bf16 v[84:87], v[92:95], v[16:19], v[84:87]
    s_waitcnt lgkmcnt(6)
    v_mfma_f32_16x16x32_bf16 v[80:83], v[96:99], v[20:23], v[80:83]
    v_mfma_f32_16x16x32_bf16 v[84:87], v[100:103], v[20:23], v[84:87]
    s_waitcnt lgkmcnt(5)
    v_mfma_f32_16x16x32_bf16 v[80:83], v[104:107], v[24:27], v[80:83]
    v_mfma_f32_16x16x32_bf16 v[84:87], v[108:111], v[24:27], v[84:87]
    s_waitcnt lgkmcnt(4)
    v_mfma_f32_16x16x32_bf16 v[80:83], v[112:115], v[28:31], v[80:83]
    v_mfma_f32_16x16x32_bf16 v[84:87], v[116:119], v[28:31], v[84:87]
    s_waitcnt lgkmcnt(3)
    v_mfma_f32_16x16x32_bf16 v[80:83], v[120:123], v[32:35], v[80:83]
    v_mfma_f32_16x16x32_bf16 v[84:87], v[124:127], v[32:35], v[84:87]
    s_waitcnt lgkmcnt(2)
    v_mfma_f32_16x16x32_bf16 v[80:83], v[128:131], v[36:39], v[80:83]
    v_mfma_f32_16x16x32_bf16 v[84:87], v[132:135], v[36:39], v[84:87]
    s_waitcnt lgkmcnt(1)
    v_mfma_f32_16x16x32_bf16 v[80:83], v[136:139], v[40:43], v[80:83]
    v_mfma_f32_16x16x32_bf16 v[84:87], v[140:143], v[40:43], v[84:87]
    s_waitcnt lgkmcnt(0)
    v_mfma_f32_16x16x32_bf16 v[80:83], v[144:147], v[44:47], v[80:83]
    v_mfma_f32_16x16x32_bf16 v[84:87], v[148:151], v[44:47], v[84:87]
L_s2_pub2:
    s_mov_b64 exec, s[68:69]
    s_nop 5
    v_and_or_b32 v80, v80, v14, s94
    v_and_or_b32 v81, v81, v14, s95
    v_and_or_b32 v82, v82, v14, s96
    v_and_or_b32 v83, v83, v14, s97
    v_and_or_b32 v84, v84, v14, s94
    v_and_or_b32 v85, v85, v14, s95
    v_and_or_b32 v86, v86, v14, s96
    v_and_or_b32 v87, v87, v14, s97
    s_cmp_lg_u32 s47, 1
    s_cbranch_scc1 LS_58
    buffer_store_dwordx4 v[80:83], v1, s[64:67], s93 offen
    buffer_store_dwordx4 v[84:87], v1, s[64:67], s98 offen
LB_59:
    s_branch L_w_end
L_w_dn:
    s_cmp_lg_u32 s28, 7
    s_cbranch_scc1 L_hprep
    s_cmp_ge_i32 s44, 90
    s_cbranch_scc1 LE_61
    s_mov_b32 s45, 0
LW_60:
    ds_read_b32 v2, v3 offset:0
    s_add_u32 s45, s45, 1
    s_cmp_gt_u32 s45, 0x80000
    s_cbranch_scc1 LE_61
    s_waitcnt lgkmcnt(0)
    v_readfirstlane_b32 s44, v2
    s_cmp_lt_i32 s44, 90
    s_cbranch_scc1 LW_60
LE_61:
    ds_read_b64_tr_b16 v[88:89], v15 offset:0
    ds_read_b64_tr_b16 v[90:91], v15 offset:4096
    ds_read_b64_tr_b16 v[92:93], v15 offset:1024
    ds_read_b64_tr_b16 v[94:95], v15 offset:5120
    s_cmp_ge_i32 s44, 98
    s_cbranch_scc1 LE_63
    s_mov_b32 s45, 0
LW_62:
    ds_read_b32 v2, v3 offset:0
    s_add_u32 s45, s45, 1
    s_cmp_gt_u32 s45, 0x80000
    s_cbranch_scc1 LE_63
    s_waitcnt lgkmcnt(0)
    v_readfirstlane_b32 s44, v2
    s_cmp_lt_i32 s44, 98
    s_cbranch_scc1 LW_62
LE_63:
    ds_read_b64_tr_b16 v[96:97], v15 offset:8192
    ds_read_b64_tr_b16 v[98:99], v15 offset:12288
    ds_read_b64_tr_b16 v[100:101], v15 offset:9216
    ds_read_b64_tr_b16 v[102:103], v15 offset:13312
    s_cmp_ge_i32 s44, 106
    s_cbranch_scc1 LE_65
    s_mov_b32 s45, 0
LW_64:
    ds_read_b32 v2, v3 offset:0
    s_add_u32 s45, s45, 1
    s_cmp_gt_u32 s45, 0x80000
    s_cbranch_scc1 LE_65
    s_waitcnt lgkmcnt(0)
    v_readfirstlane_b32 s44, v2
    s_cmp_lt_i32 s44, 106
    s_cbranch_scc1 LW_64
LE_65:
    ds_read_b64_tr_b16 v[104:105], v15 offset:16384
    ds_read_b64_tr_b16 v[106:107], v15 offset:20480
    ds_read_b64_tr_b16 v[108:109], v15 offset:17408
    ds_read_b64_tr_b16 v[110:111], v15 offset:21504
    s_cmp_ge_i32 s44, 114
    s_cbranch_scc1 LE_67
    s_mov_b32 s45, 0
LW_66:
    ds_read_b32 v2, v3 offset:0
    s_add_u32 s45, s45, 1
    s_cmp_gt_u32 s45, 0x80000
    s_cbranch_scc1 LE_67
    s_waitcnt lgkmcnt(0)
    v_readfirstlane_b32 s44, v2
    s_cmp_lt_i32 s44, 114
    s_cbranch_scc1 LW_66
LE_67:
    ds_read_b64_tr_b16 v[112:113], v15 offset:24576
    ds_read_b64_tr_b16 v[114:115], v15 offset:28672
    ds_read_b64_tr_b16 v[116:117], v15 offset:25600
    ds_read_b64_tr_b16 v[118:119], v15 offset:29696
L_hprep:
    s_mul_i32 s40, s90, 36
    v_add_u32 v5, s40, v0
    v_lshlrev_b32 v60, 4, v5
    s_lshl_b32 s40, s37, 3
    s_add_u32 s48, s40, 135168
    s_add_u32 s49, s48, 36864
    s_add_u32 s50, s48, 73728
    s_add_u32 s51, s48, 110592
    s_add_u32 s52, s48, 147456
    s_add_u32 s53, s48, 184320
    v_bfe_u32 v4, v5, 2, 1
    v_mul_u32_u24 v62, 704, v4
    v_lshrrev_b32 v4, 4, v5
    v_lshl_add_u32 v62, v4, 6, v62
    v_and_b32 v4, 3, v5
    v_lshl_add_u32 v62, v4, 4, v62
    v_bfe_u32 v4, v5, 3, 1
    v_lshl_add_u32 v62, v4, 3, v62
    s_mov_b32 s54, 0xbdd2d3e8
    v_mov_b32 v64, 0xc0135761
    s_mov_b32 s55, 0xffff0000
    s_mov_b32 s92, 110
    s_cmp_eq_u32 s36, 82
    s_cselect_b32 s92, 114, s92
    s_cmp_ge_i32 s44, s92
    s_cbranch_scc1 LE_69
    s_mov_b32 s45, 0
LW_68:
    ds_read_b32 v2, v3 offset:0
    s_add_u32 s45, s45, 1
    s_cmp_gt_u32 s45, 0x80000
    s_cbranch_scc1 LE_69
    s_waitcnt lgkmcnt(0)
    v_readfirstlane_b32 s44, v2
    s_cmp_lt_i32 s44, s92
    s_cbranch_scc1 LW_68
LE_69:
    s_mov_b32 exec_hi, 15
    s_mov_b32 s45, 0
L_h_poll:
    buffer_load_dwordx4 v[16:19], v60, s[60:63], s48 offen sc1
    buffer_load_dwordx4 v[20:23], v60, s[60:63], s49 offen sc1
    buffer_load_dwordx4 v[24:27], v60, s[60:63], s50 offen sc1
    buffer_load_dwordx4 v[28:31], v60, s[60:63], s51 offen sc1
    buffer_load_dwordx4 v[32:35], v60, s[60:63], s52 offen sc1
    buffer_load_dwordx4 v[36:39], v60, s[60:63], s53 offen sc1
    s_add_u32 s45, s45, 1
    s_cmp_gt_u32 s45, 0x8000
    s_cbranch_scc1 L_h_ok
    s_waitcnt vmcnt(0)
    v_xor_b32 v16, s94, v16
    v_xor_b32 v17, s95, v17
    v_xor_b32 v18, s96, v18
    v_xor_b32 v19, s97, v19
    v_or3_b32 v4, v16, v17, v18
    v_or_b32 v4, v4, v19
    v_xor_b32 v20, s94, v20
    v_xor_b32 v21, s95, v21
    v_xor_b32 v22, s96, v22
    v_xor_b32 v23, s97, v23
    v_or3_b32 v4, v4, v20, v21
    v_or3_b32 v4, v4, v22, v23
    v_xor_b32 v24, s94, v24
    v_xor_b32 v25, s95, v25
    v_xor_b32 v26, s96, v26
    v_xor_b32 v27, s97, v27
    v_or3_b32 v4, v4, v24, v25
    v_or3_b32 v4, v4, v26, v27
    v_xor_b32 v28, s94, v28
    v_xor_b32 v29, s95, v29
    v_xor_b32 v30, s96, v30
    v_xor_b32 v31, s97, v31
    v_or3_b32 v4, v4, v28, v29
    v_or3_b32 v4, v4, v30, v31
    v_xor_b32 v32, s94, v32
    v_xor_b32 v33, s95, v33
    v_xor_b32 v34, s96, v34
    v_xor_b32 v35, s97, v35
    v_or3_b32 v4, v4, v32, v33
    v_or3_b32 v4, v4, v34, v35
    v_xor_b32 v36, s94, v36
    v_xor_b32 v37, s95, v37
    v_xor_b32 v38, s96, v38
    v_xor_b32 v39, s97, v39
    v_or3_b32 v4, v4, v36, v37
    v_or3_b32 v4, v4, v38, v39
    v_and_b32 v4, 0xff, v4
    v_cmp_ne_u32 vcc, 0, v4
    s_and_b64 exec, exec, vcc
    s_cbranch_vccnz L_h_poll
L_h_ok:
    s_mov_b32 exec_lo, -1
    s_mov_b32 exec_hi, 15
    s_waitcnt vmcnt(0)
    v_add_f32 v16, v16, v20
    v_add_f32 v17, v17, v21
    v_add_f32 v18, v18, v22
    v_add_f32 v19, v19, v23
    v_add_f32 v16, v16, v24
    v_add_f32 v17, v17, v25
    v_add_f32 v18, v18, v26
    v_add_f32 v19, v19, v27
    v_cvt_pk_bf16_f32 v20, v16, v17
    v_cvt_pk_bf16_f32 v21, v18, v19
    v_lshlrev_b32 v16, 16, v20
    v_and_b32 v17, s55, v20
    v_lshlrev_b32 v18, 16, v21
    v_and_b32 v19, s55, v21
    v_add_f32 v28, v28, v32
    v_add_f32 v29, v29, v33
    v_add_f32 v30, v30, v34
    v_add_f32 v31, v31, v35
    v_add_f32 v28, v28, v36
    v_add_f32 v29, v29, v37
    v_add_f32 v30, v30, v38
    v_add_f32 v31, v31, v39
    v_cvt_pk_bf16_f32 v32, v28, v29
    v_cvt_pk_bf16_f32 v33, v30, v31
    v_lshlrev_b32 v28, 16, v32
    v_and_b32 v29, s55, v32
    v_lshlrev_b32 v30, 16, v33
    v_and_b32 v31, s55, v33
    v_mul_f32 v4, v16, v16
    v_mul_f32 v5, v17, v17
    v_mul_f32 v6, v18, v18
    v_mul_f32 v7, v19, v19
    v_fma_f32 v4, v4, s54, v64
    v_fma_f32 v5, v5, s54, v64
    v_fma_f32 v6, v6, s54, v64
    v_fma_f32 v7, v7, s54, v64
    v_mul_f32 v4, v4, v16
    v_mul_f32 v5, v5, v17
    v_mul_f32 v6, v6, v18
    v_mul_f32 v7, v7, v19
    v_exp_f32 v4, v4
    v_exp_f32 v5, v5
    v_exp_f32 v6, v6
    v_exp_f32 v7, v7
    s_nop 0
    v_add_f32 v4, 1.0, v4
    v_add_f32 v5, 1.0, v5
    v_add_f32 v6, 1.0, v6
    v_add_f32 v7, 1.0, v7
    v_rcp_f32 v4, v4
    v_rcp_f32 v5, v5
    v_rcp_f32 v6, v6
    v_rcp_f32 v7, v7
    s_nop 0
    v_mul_f32 v4, v4, v16
    v_mul_f32 v5, v5, v17
    v_mul_f32 v6, v6, v18
    v_mul_f32 v7, v7, v19
    v_cvt_pk_bf16_f32 v20, v4, v5
    v_cvt_pk_bf16_f32 v21, v6, v7
    v_lshlrev_b32 v4, 16, v20
    v_and_b32 v5, s55, v20
    v_lshlrev_b32 v6, 16, v21
    v_and_b32 v7, s55, v21
    v_mul_f32 v4, v4, v28
    v_mul_f32 v5, v5, v29
    v_mul_f32 v6, v6, v30
    v_mul_f32 v7, v7, v31
    v_cvt_pk_bf16_f32 v20, v4, v5
    v_cvt_pk_bf16_f32 v21, v6, v7
    ds_write_b64 v62, v[20:21] offset:3072
    s_mov_b64 exec, 1
    v_mov_b32 v6, 1
    ds_add_u32 v3, v6 offset:24
    s_mov_b64 exec, -1
    s_cmp_eq_u32 s28, 7
    s_cbranch_scc1 L_dn2
    s_mov_b32 s45, 0
LW_70:
    ds_read_b32 v2, v3 offset:24
    s_add_u32 s45, s45, 1
    s_cmp_gt_u32 s45, 0x80000
    s_cbranch_scc1 LE_71
    s_waitcnt lgkmcnt(0)
    v_readfirstlane_b32 s43, v2
    s_cmp_lt_i32 s43, 4
    s_cbranch_scc1 LW_70
LE_71:
    ds_read_b128 v[16:19], v11 offset:3072
    ds_read_b128 v[20:23], v11 offset:3136
    ds_read_b128 v[24:27], v11 offset:3200
    ds_read_b128 v[28:31], v11 offset:3264
    ds_read_b128 v[32:35], v11 offset:3328
    ds_read_b128 v[36:39], v11 offset:3392
    ds_read_b128 v[40:43], v11 offset:3456
    ds_read_b128 v[44:47], v11 offset:3520
    ds_read_b128 v[48:51], v11 offset:3584
    s_add_u32 s92, s36, 4
    s_cmp_ge_i32 s44, s92
    s_cbranch_scc1 LE_73
    s_mov_b32 s45, 0
LW_72:
    ds_read_b32 v2, v3 offset:0
    s_add_u32 s45, s45, 1
    s_cmp_gt_u32 s45, 0x80000
    s_cbranch_scc1 LE_73
    s_waitcnt lgkmcnt(0)
    v_readfirstlane_b32 s44, v2
    s_cmp_lt_i32 s44, s92
    s_cbranch_scc1 LW_72
LE_73:
    ds_read_b64_tr_b16 v[88:89], v10 offset:0
    ds_read_b64_tr_b16 v[90:91], v10 offset:2048
    s_add_u32 s92, s92, 4
    s_cmp_lt_i32 s44, s92
    s_cbranch_scc1 LS_74
LB_75:
    ds_read_b64_tr_b16 v[92:93], v10 offset:4096
    ds_read_b64_tr_b16 v[94:95], v10 offset:6144
    s_add_u32 s92, s92, 4
    s_cmp_lt_i32 s44, s92
    s_cbranch_scc1 LS_76
LB_77:
    ds_read_b64_tr_b16 v[96:97], v10 offset:8192
    ds_read_b64_tr_b16 v[98:99], v10 offset:10240
    s_add_u32 s92, s92, 4
    s_waitcnt lgkmcnt(4)
    v_mfma_f32_16x16x32_bf16 v[80:83], v[88:91], v[16:19], v[80:83]
    s_cmp_lt_i32 s44, s92
    s_cbranch_scc1 LS_78
LB_79:
    ds_read_b64_tr_b16 v[100:101], v10 offset:12288
    ds_read_b64_tr_b16 v[102:103], v10 offset:14336
    s_add_u32 s92, s92, 4
    s_waitcnt lgkmcnt(4)
    v_mfma_f32_16x16x32_bf16 v[80:83], v[92:95], v[20:23], v[80:83]
    s_cmp_lt_i32 s44, s92
    s_cbranch_scc1 LS_80
LB_81:
    ds_read_b64_tr_b16 v[104:105], v10 offset:16384
    ds_read_b64_tr_b16 v[106:107], v10 offset:18432
    s_add_u32 s92, s92, 4
    s_waitcnt lgkmcnt(4)
    v_mfma_f32_16x16x32_bf16 v[80:83], v[96:99], v[24:27], v[80:83]
    s_cmp_lt_i32 s44, s92
    s_cbranch_scc1 LS_82
LB_83:
    ds_read_b64_tr_b16 v[108:109], v10 offset:20480
    ds_read_b64_tr_b16 v[110:111], v10 offset:22528
    s_add_u32 s92, s92, 4
    s_waitcnt lgkmcnt(4)
    v_mfma_f32_16x16x32_bf16 v[80:83], v[100:103], v[28:31], v[80:83]
    s_cmp_lt_i32 s44, s92
    s_cbranch_scc1 LS_84
LB_85:
    ds_read_b64_tr_b16 v[112:113], v10 offset:24576
    ds_read_b64_tr_b16 v[114:115], v10 offset:26624
    s_add_u32 s92, s92, 4
    s_waitcnt lgkmcnt(4)
    v_mfma_f32_16x16x32_bf16 v[80:83], v[104:107], v[32:35], v[80:83]
    s_cmp_lt_i32 s44, s92
    s_cbranch_scc1 LS_86
LB_87:
    ds_read_b64_tr_b16 v[116:117], v10 offset:28672
    ds_read_b64_tr_b16 v[118:119], v10 offset:30720
    s_add_u32 s92, s92, 4
    s_waitcnt lgkmcnt(4)
    v_mfma_f32_16x16x32_bf16 v[80:83], v[108:111], v[36:39], v[80:83]
    s_cmp_ge_i32 s44, s92
    s_cbranch_scc1 LE_89
    s_mov_b32 s45, 0
LW_88:
    ds_read_b32 v2, v3 offset:0
    s_add_u32 s45, s45, 1
    s_cmp_gt_u32 s45, 0x80000
    s_cbranch_scc1 LE_89
    s_waitcnt lgkmcnt(0)
    v_readfirstlane_b32 s44, v2
    s_cmp_lt_i32 s44, s92
    s_cbranch_scc1 LW_88
LE_89:
    ds_read_b64_tr_b16 v[120:121], v10 offset:32768
    ds_read_b64_tr_b16 v[122:123], v10 offset:34816
    s_waitcnt lgkmcnt(4)
    v_mfma_f32_16x16x32_bf16 v[80:83], v[112:115], v[40:43], v[80:83]
    s_waitcnt lgkmcnt(2)
    v_mfma_f32_16x16x32_bf16 v[80:83], v[116:119], v[44:47], v[80:83]
    s_waitcnt lgkmcnt(0)
    v_mfma_f32_16x16x32_bf16 v[80:83], v[120:123], v[48:51], v[80:83]
    s_branch L_s2_pub
L_dn2:
    s_cmp_ge_i32 s44, 122
    s_cbranch_scc1 LE_91
    s_mov_b32 s45, 0
LW_90:
    ds_read_b32 v2, v3 offset:0
    s_add_u32 s45, s45, 1
    s_cmp_gt_u32 s45, 0x80000
    s_cbranch_scc1 LE_91
    s_waitcnt lgkmcnt(0)
    v_readfirstlane_b32 s44, v2
    s_cmp_lt_i32 s44, 122
    s_cbranch_scc1 LW_90
LE_91:
    ds_read_b64_tr_b16 v[120:121], v15 offset:32768
    ds_read_b64_tr_b16 v[122:123], v15 offset:36864
    ds_read_b64_tr_b16 v[124:125], v15 offset:33792
    ds_read_b64_tr_b16 v[126:127], v15 offset:37888
    s_cmp_ge_i32 s44, 130
    s_cbranch_scc1 LE_93
    s_mov_b32 s45, 0
LW_92:
    ds_read_b32 v2, v3 offset:0
    s_add_u32 s45, s45, 1
    s_cmp_gt_u32 s45, 0x80000
    s_cbranch_scc1 LE_93
    s_waitcnt lgkmcnt(0)
    v_readfirstlane_b32 s44, v2
    s_cmp_lt_i32 s44, 130
    s_cbranch_scc1 LW_92
LE_93:
    ds_read_b64_tr_b16 v[128:129], v15 offset:40960
    ds_read_b64_tr_b16 v[130:131], v15 offset:45056
    ds_read_b64_tr_b16 v[132:133], v15 offset:41984
    ds_read_b64_tr_b16 v[134:135], v15 offset:46080
    s_cmp_ge_i32 s44, 138
    s_cbranch_scc1 LE_95
    s_mov_b32 s45, 0
LW_94:
    ds_read_b32 v2, v3 offset:0
    s_add_u32 s45, s45, 1
    s_cmp_gt_u32 s45, 0x80000
    s_cbranch_scc1 LE_95
    s_waitcnt lgkmcnt(0)
    v_readfirstlane_b32 s44, v2
    s_cmp_lt_i32 s44, 138
    s_cbranch_scc1 LW_94
LE_95:
    ds_read_b64_tr_b16 v[136:137], v15 offset:49152
    ds_read_b64_tr_b16 v[138:139], v15 offset:53248
    ds_read_b64_tr_b16 v[140:141], v15 offset:50176
    ds_read_b64_tr_b16 v[142:143], v15 offset:54272
    s_mov_b32 s45, 0
LW_96:
    ds_read_b32 v2, v3 offset:24
    s_add_u32 s45, s45, 1
    s_cmp_gt_u32 s45, 0x80000
    s_cbranch_scc1 LE_97
    s_waitcnt lgkmcnt(0)
    v_readfirstlane_b32 s43, v2
    s_cmp_lt_i32 s43, 4
    s_cbranch_scc1 LW_96
LE_97:
    ds_read_b128 v[16:19], v11 offset:3072
    ds_read_b128 v[20:23], v11 offset:3136
    ds_read_b128 v[24:27], v11 offset:3200
    ds_read_b128 v[28:31], v11 offset:3264
    ds_read_b128 v[32:35], v11 offset:3328
    ds_read_b128 v[36:39], v11 offset:3392
    ds_read_b128 v[40:43], v11 offset:3456
    ds_read_b128 v[44:47], v11 offset:3520
    ds_read_b128 v[48:51], v11 offset:3584
    s_waitcnt lgkmcnt(8)
    v_mfma_f32_16x16x32_bf16 v[80:83], v[88:91], v[16:19], v[80:83]
    v_mfma_f32_16x16x32_bf16 v[84:87], v[92:95], v[16:19], v[84:87]
    s_waitcnt lgkmcnt(7)
    v_mfma_f32_16x16x32_bf16 v[80:83], v[96:99], v[20:23], v[80:83]
    v_mfma_f32_16x16x32_bf16 v[84:87], v[100:103], v[20:23], v[84:87]
    s_waitcnt lgkmcnt(6)
    v_mfma_f32_16x16x32_bf16 v[80:83], v[104:107], v[24:27], v[80:83]
    v_mfma_f32_16x16x32_bf16 v[84:87], v[108:111], v[24:27], v[84:87]
    s_waitcnt lgkmcnt(5)
    v_mfma_f32_16x16x32_bf16 v[80:83], v[112:115], v[28:31], v[80:83]
    v_mfma_f32_16x16x32_bf16 v[84:87], v[116:119], v[28:31], v[84:87]
    s_waitcnt lgkmcnt(4)
    v_mfma_f32_16x16x32_bf16 v[80:83], v[120:123], v[32:35], v[80:83]
    v_mfma_f32_16x16x32_bf16 v[84:87], v[124:127], v[32:35], v[84:87]
    s_waitcnt lgkmcnt(3)
    v_mfma_f32_16x16x32_bf16 v[80:83], v[128:131], v[36:39], v[80:83]
    v_mfma_f32_16x16x32_bf16 v[84:87], v[132:135], v[36:39], v[84:87]
    s_waitcnt lgkmcnt(2)
    v_mfma_f32_16x16x32_bf16 v[80:83], v[136:139], v[40:43], v[80:83]
    v_mfma_f32_16x16x32_bf16 v[84:87], v[140:143], v[40:43], v[84:87]
    s_cmp_ge_i32 s44, 146
    s_cbranch_scc1 LE_99
    s_mov_b32 s45, 0
LW_98:
    ds_read_b32 v2, v3 offset:0
    s_add_u32 s45, s45, 1
    s_cmp_gt_u32 s45, 0x80000
    s_cbranch_scc1 LE_99
    s_waitcnt lgkmcnt(0)
    v_readfirstlane_b32 s44, v2
    s_cmp_lt_i32 s44, 146
    s_cbranch_scc1 LW_98
LE_99:
    ds_read_b64_tr_b16 v[144:145], v15 offset:57344
    ds_read_b64_tr_b16 v[146:147], v15 offset:61440
    ds_read_b64_tr_b16 v[148:149], v15 offset:58368
    ds_read_b64_tr_b16 v[150:151], v15 offset:62464
    s_cmp_ge_i32 s44, 154
    s_cbranch_scc1 LE_101
    s_mov_b32 s45, 0
LW_100:
    ds_read_b32 v2, v3 offset:0
    s_add_u32 s45, s45, 1
    s_cmp_gt_u32 s45, 0x80000
    s_cbranch_scc1 LE_101
    s_waitcnt lgkmcnt(0)
    v_readfirstlane_b32 s44, v2
    s_cmp_lt_i32 s44, 154
    s_cbranch_scc1 LW_100
LE_101:
    ds_read_b64_tr_b16 v[56:57], v13 offset:0
    ds_read_b64_tr_b16 v[58:59], v13 offset:4096
    ds_read_b64_tr_b16 v[60:61], v13 offset:1024
    ds_read_b64_tr_b16 v[62:63], v13 offset:5120
    s_waitcnt lgkmcnt(4)
    v_mfma_f32_16x16x32_bf16 v[80:83], v[144:147], v[44:47], v[80:83]
    v_mfma_f32_16x16x32_bf16 v[84:87], v[148:151], v[44:47], v[84:87]
    s_waitcnt lgkmcnt(0)
    v_mfma_f32_16x16x32_bf16 v[80:83], v[56:59], v[48:51], v[80:83]
    v_mfma_f32_16x16x32_bf16 v[84:87], v[60:63], v[48:51], v[84:87]
    s_branch L_s2_pub2
LS_58:
    buffer_store_dwordx4 v[80:83], v1, s[64:67], s93 offen sc1
    buffer_store_dwordx4 v[84:87], v1, s[64:67], s98 offen sc1
    s_branch LB_59
LS_74:
    s_cmp_ge_i32 s44, s92
    s_cbranch_scc1 LE_103
    s_mov_b32 s45, 0
LW_102:
    ds_read_b32 v2, v3 offset:0
    s_add_u32 s45, s45, 1
    s_cmp_gt_u32 s45, 0x80000
    s_cbranch_scc1 LE_103
    s_waitcnt lgkmcnt(0)
    v_readfirstlane_b32 s44, v2
    s_cmp_lt_i32 s44, s92
    s_cbranch_scc1 LW_102
LE_103:
    s_branch LB_75
LS_76:
    s_cmp_ge_i32 s44, s92
    s_cbranch_scc1 LE_105
    s_mov_b32 s45, 0
LW_104:
    ds_read_b32 v2, v3 offset:0
    s_add_u32 s45, s45, 1
    s_cmp_gt_u32 s45, 0x80000
    s_cbranch_scc1 LE_105
    s_waitcnt lgkmcnt(0)
    v_readfirstlane_b32 s44, v2
    s_cmp_lt_i32 s44, s92
    s_cbranch_scc1 LW_104
LE_105:
    s_branch LB_77
LS_78:
    s_cmp_ge_i32 s44, s92
    s_cbranch_scc1 LE_107
    s_mov_b32 s45, 0
LW_106:
    ds_read_b32 v2, v3 offset:0
    s_add_u32 s45, s45, 1
    s_cmp_gt_u32 s45, 0x80000
    s_cbranch_scc1 LE_107
    s_waitcnt lgkmcnt(0)
    v_readfirstlane_b32 s44, v2
    s_cmp_lt_i32 s44, s92
    s_cbranch_scc1 LW_106
LE_107:
    s_branch LB_79
LS_80:
    s_cmp_ge_i32 s44, s92
    s_cbranch_scc1 LE_109
    s_mov_b32 s45, 0
LW_108:
    ds_read_b32 v2, v3 offset:0
    s_add_u32 s45, s45, 1
    s_cmp_gt_u32 s45, 0x80000
    s_cbranch_scc1 LE_109
    s_waitcnt lgkmcnt(0)
    v_readfirstlane_b32 s44, v2
    s_cmp_lt_i32 s44, s92
    s_cbranch_scc1 LW_108
LE_109:
    s_branch LB_81
LS_82:
    s_cmp_ge_i32 s44, s92
    s_cbranch_scc1 LE_111
    s_mov_b32 s45, 0
LW_110:
    ds_read_b32 v2, v3 offset:0
    s_add_u32 s45, s45, 1
    s_cmp_gt_u32 s45, 0x80000
    s_cbranch_scc1 LE_111
    s_waitcnt lgkmcnt(0)
    v_readfirstlane_b32 s44, v2
    s_cmp_lt_i32 s44, s92
    s_cbranch_scc1 LW_110
LE_111:
    s_branch LB_83
LS_84:
    s_cmp_ge_i32 s44, s92
    s_cbranch_scc1 LE_113
    s_mov_b32 s45, 0
LW_112:
    ds_read_b32 v2, v3 offset:0
    s_add_u32 s45, s45, 1
    s_cmp_gt_u32 s45, 0x80000
    s_cbranch_scc1 LE_113
    s_waitcnt lgkmcnt(0)
    v_readfirstlane_b32 s44, v2
    s_cmp_lt_i32 s44, s92
    s_cbranch_scc1 LW_112
LE_113:
    s_branch LB_85
LS_86:
    s_cmp_ge_i32 s44, s92
    s_cbranch_scc1 LE_115
    s_mov_b32 s45, 0
LW_114:
    ds_read_b32 v2, v3 offset:0
    s_add_u32 s45, s45, 1
    s_cmp_gt_u32 s45, 0x80000
    s_cbranch_scc1 LE_115
    s_waitcnt lgkmcnt(0)
    v_readfirstlane_b32 s44, v2
    s_cmp_lt_i32 s44, s92
    s_cbranch_scc1 LW_114
LE_115:
    s_branch LB_87
L_att:
    s_sub_u32 s90, s32, 5
    v_lshrrev_b32 v10, 2, v9
    v_mul_u32_u24 v10, 1088, v10
    v_and_b32 v11, 3, v0
    v_lshl_add_u32 v10, v11, 8, v10
    v_xor_b32 v11, v11, v8
    v_lshl_add_u32 v10, v11, 4, v10
    s_mul_i32 s40, s90, 8704
    s_add_u32 s40, s40, 92160
    v_add_u32 v10, s40, v10
    v_mul_u32_u24 v12, 1152, v8
    v_lshrrev_b32 v11, 2, v9
    v_lshl_add_u32 v12, v11, 8, v12
    v_lshlrev_b32 v11, 5, v11
    s_lshl_b32 s40, s90, 6
    v_xor_b32 v11, s40, v11
    v_add_u32 v12, v12, v11
    v_and_b32 v11, 3, v0
    v_lshl_add_u32 v12, v11, 3, v12
    v_add_u32 v72, 126976, v12
    v_xor_b32 v73, 32, v72
    v_lshlrev_b32 v1, 6, v9
    v_lshl_add_u32 v1, v8, 4, v1
    v_cmp_gt_u32 vcc, 2, v9
    s_mov_b64 s[68:69], vcc
    s_waitcnt lgkmcnt(0)
    s_mul_i32 s46, s46, 1664525
    s_add_u32 s46, s46, 1013904223
    s_and_b32 s94, s46, 0xff
    s_bfe_u32 s95, s46, 0x80008
    s_bfe_u32 s96, s46, 0x80010
    s_lshr_b32 s97, s46, 24
    s_cmp_lg_u32 s90, 1
    s_cbranch_scc1 L_a_nov
    s_getreg_b32 s42, hwreg(HW_REG_XCC_ID, 0, 4)
    s_lshl_b32 s40, s28, 8
    s_add_u32 s40, s40, 1421312
    s_lshl3_add_u32 s41, s29, s40
    v_mov_b32 v4, s46
    v_mov_b32 v5, s42
    v_lshlrev_b32 v11, 3, v0
    s_mov_b64 exec, 1
    buffer_store_dwordx2 v[4:5], v3, s[64:67], s41 offen
    s_mov_b64 exec, -1
    s_cmp_ge_i32 s44, 30
    s_cbranch_scc1 LE_117
    s_mov_b32 s45, 0
LW_116:
    ds_read_b32 v2, v3 offset:0
    s_add_u32 s45, s45, 1
    s_cmp_gt_u32 s45, 0x80000
    s_cbranch_scc1 LE_117
    s_waitcnt lgkmcnt(0)
    v_readfirstlane_b32 s44, v2
    s_cmp_lt_i32 s44, 30
    s_cbranch_scc1 LW_116
LE_117:
    s_mov_b32 exec_hi, 0
    s_mov_b32 s45, 0
L_a_vpoll:
    buffer_load_dwordx2 v[6:7], v11, s[64:67], s40 offen nt
    s_add_u32 s45, s45, 1
    s_cmp_lt_u32 s45, 3
    s_cbranch_scc1 L_a_v1
    s_cmp_lg_u32 s45, 3
    s_cbranch_scc1 L_a_v2
    s_mov_b64 exec, 1
    buffer_store_dwordx2 v[4:5], v3, s[64:67], s41 offen offset:2048 sc1
    s_mov_b32 exec_lo, -1
L_a_v2:
    buffer_load_dwordx2 v[16:17], v11, s[64:67], s40 offen offset:2048 sc1
    s_waitcnt vmcnt(0)
    v_cmp_eq_u32 vcc, s46, v16
    s_nop 1
    v_cndmask_b32 v6, v6, v16, vcc
    v_cndmask_b32 v7, v7, v17, vcc
    s_cmp_gt_u32 s45, 0x8000
    s_cbranch_scc1 L_a_vok
L_a_v1:
    s_waitcnt vmcnt(0)
    v_cmp_ne_u32 vcc, s46, v6
    s_cbranch_vccnz L_a_vpoll
L_a_vok:
    v_cmp_ne_u32 vcc, s42, v7
    s_cmp_eq_u64 vcc, 0
    s_cselect_b32 s40, 1, 2
    v_mov_b32 v6, s40
    ds_write_b32 v3, v6 offset:32
    s_cmp_eq_u32 s40, 1
    s_cbranch_scc1 L_a_vend
    s_mov_b64 exec, 1
    buffer_store_dwordx2 v[4:5], v3, s[64:67], s41 offen offset:2048 sc1
    s_mov_b32 exec_lo, -1
L_a_vend:
    s_mov_b64 exec, -1
L_a_nov:
    s_cmp_lg_u32 s90, 0
    s_cbranch_scc1 L_a_k
    s_cmp_ge_i32 s44, 54
    s_cbranch_scc1 LE_119
    s_mov_b32 s45, 0
LW_118:
    ds_read_b32 v2, v3 offset:0
    s_add_u32 s45, s45, 1
    s_cmp_gt_u32 s45, 0x80000
    s_cbranch_scc1 LE_119
    s_waitcnt lgkmcnt(0)
    v_readfirstlane_b32 s44, v2
    s_cmp_lt_i32 s44, 54
    s_cbranch_scc1 LW_118
LE_119:
    v_lshrrev_b32 v11, 2, v0
    v_lshlrev_b32 v11, 7, v11
    v_and_b32 v12, 3, v0
    v_lshl_add_u32 v11, v12, 4, v11
    s_lshl_b32 s40, s30, 13
    s_lshr_b32 s41, s31, 3
    s_lshl_b32 s41, s41, 6
    s_add_u32 s40, s40, s41
    s_add_u32 s40, s40, 4096
    s_add_u32 s41, s40, 4096
    s_mov_b32 s45, 0
    s_mov_b32 s47, 1
    s_mov_b32 s53, 0
L_a_qpoll:
    s_cmp_lg_u32 s47, 1
    s_cbranch_scc1 LS_120
    buffer_load_dwordx4 v[16:19], v11, s[64:67], s40 offen offset:0 nt
    buffer_load_dwordx4 v[20:23], v11, s[64:67], s40 offen offset:2048 nt
    buffer_load_dwordx4 v[24:27], v11, s[64:67], s41 offen offset:0 nt
    buffer_load_dwordx4 v[28:31], v11, s[64:67], s41 offen offset:2048 nt
LB_121:
    s_add_u32 s53, s53, 1
    s_cmp_gt_u32 s53, 0x8000
    s_cbranch_scc1 L_a_qok
    s_waitcnt vmcnt(0)
    v_xor_b32 v16, s94, v16
    v_xor_b32 v17, s95, v17
    v_xor_b32 v18, s96, v18
    v_xor_b32 v19, s97, v19
    v_or3_b32 v4, v16, v17, v18
    v_or_b32 v4, v4, v19
    v_xor_b32 v20, s94, v20
    v_xor_b32 v21, s95, v21
    v_xor_b32 v22, s96, v22
    v_xor_b32 v23, s97, v23
    v_or3_b32 v4, v4, v20, v21
    v_or3_b32 v4, v4, v22, v23
    v_xor_b32 v24, s94, v24
    v_xor_b32 v25, s95, v25
    v_xor_b32 v26, s96, v26
    v_xor_b32 v27, s97, v27
    v_or3_b32 v4, v4, v24, v25
    v_or3_b32 v4, v4, v26, v27
    v_xor_b32 v28, s94, v28
    v_xor_b32 v29, s95, v29
    v_xor_b32 v30, s96, v30
    v_xor_b32 v31, s97, v31
    v_or3_b32 v4, v4, v28, v29
    v_or3_b32 v4, v4, v30, v31
    v_and_b32 v4, 0xff, v4
    v_cmp_ne_u32 vcc, 0, v4
    s_cbranch_vccz L_a_qok
    s_mov_b32 s47, 0
    s_cmp_ge_i32 s47, 1
    s_cbranch_scc1 LE_123
    s_mov_b32 s45, 0
LW_122:
    ds_read_b32 v2, v3 offset:32
    s_add_u32 s45, s45, 1
    s_cmp_gt_u32 s45, 0x80000
    s_cbranch_scc1 LE_123
    s_waitcnt lgkmcnt(0)
    v_readfirstlane_b32 s47, v2
    s_cmp_lt_i32 s47, 1
    s_cbranch_scc1 LW_122
LE_123:
    s_branch L_a_qpoll
L_a_qok:
    s_mov_b32 s47, 0
    s_waitcnt vmcnt(0)
    v_add_f32 v16, v16, v20
    v_add_f32 v24, v24, v28
    v_add_f32 v16, v16, v24
    v_add_f32 v17, v17, v21
    v_add_f32 v25, v25, v29
    v_add_f32 v17, v17, v25
    v_add_f32 v18, v18, v22
    v_add_f32 v26, v26, v30
    v_add_f32 v18, v18, v26
    v_add_f32 v19, v19, v23
    v_add_f32 v27, v27, v31
    v_add_f32 v19, v19, v27
    v_cvt_pk_bf16_f32 v4, v16, v17
    v_cvt_pk_bf16_f32 v5, v18, v19
    v_lshlrev_b32 v11, 3, v0
    v_mov_b32 v6, 1
    ds_write_b64 v11, v[4:5] offset:2560
    ds_write_b32 v3, v6 offset:16
L_a_k:
    v_and_b32 v12, 1, v0
    v_lshlrev_b32 v74, 6, v12
    v_lshl_add_u32 v74, v8, 4, v74
    s_lshl_b32 s43, s90, 7
    v_add_u32 v75, s43, v74
    v_lshlrev_b32 v80, 2, v12
    v_add_u32 v80, 4480, v80
    s_lshl_b32 s43, s90, 3
    v_add_u32 v81, s43, v80
    v_lshlrev_b32 v11, 8, v12
    v_lshl_add_u32 v11, v8, 4, v11
    s_lshl4_add_u32 s40, s30, s31
    s_lshl2_add_u32 s40, s40, s90
    s_lshl_b32 s40, s40, 8
    s_add_u32 s93, s40, 356352
    v_lshrrev_b32 v12, 5, v0
    v_and_b32 v82, 31, v0
    v_lshlrev_b32 v82, 4, v82
    v_lshl_add_u32 v82, v12, 12, v82
    s_lshl_b32 s40, s33, 14
    s_lshr_b32 s41, s90, 1
    s_lshl_b32 s41, s41, 13
    s_add_u32 s40, s40, s41
    s_and_b32 s41, s90, 1
    s_lshl_b32 s41, s41, 9
    s_add_u32 s40, s40, s41
    s_add_u32 s57, s40, 356352
    v_bfe_u32 v83, v0, 2, 1
    v_lshlrev_b32 v83, 8, v83
    v_lshl_add_u32 v83, v12, 2, v83
    v_bfe_u32 v12, v0, 4, 1
    v_lshl_add_u32 v83, v12, 6, v83
    v_and_b32 v12, 3, v0
    v_lshl_add_u32 v83, v12, 4, v83
    v_bfe_u32 v12, v0, 3, 1
    v_lshl_add_u32 v83, v12, 3, v83
    s_lshr_b32 s42, s90, 1
    s_mul_i32 s42, s42, 704
    s_lshr_b32 s41, s41, 2
    s_add_u32 s42, s42, s41
    v_add_u32 v83, s42, v83
    s_mov_b32 s92, 0x625a421a
    s_cmp_eq_u32 s36, 82
    s_cselect_b32 s92, 0x322a221a, s92
    s_lshl_b32 s43, s90, 3
    s_lshr_b32 s92, s92, s43
    s_and_b32 s92, s92, 0xff
    v_mov_b32 v64, 0
    v_mov_b32 v65, 0
    v_mov_b32 v66, 0
    v_mov_b32 v67, 0
    v_mov_b32 v68, 0
    v_mov_b32 v69, 0
    v_mov_b32 v70, 0
    v_mov_b32 v71, 0
    s_mov_b32 s40, 0xffff0000
    s_mov_b32 s41, 0x3db504f3
    s_mov_b32 s42, 0x3fb8aa3b
    s_mov_b32 s45, 0
LW_124:
    ds_read_b32 v2, v3 offset:16
    s_add_u32 s45, s45, 1
    s_cmp_gt_u32 s45, 0x80000
    s_cbranch_scc1 LE_125
    s_waitcnt lgkmcnt(0)
    v_readfirstlane_b32 s43, v2
    s_cmp_lt_i32 s43, 1
    s_cbranch_scc1 LW_124
LE_125:
    ds_read_b128 v[48:51], v11 offset:2560
    ds_read_b128 v[52:55], v11 offset:2624
    ds_read_b128 v[56:59], v11 offset:2688
    ds_read_b128 v[60:63], v11 offset:2752
    s_cmp_ge_i32 s47, 1
    s_cbranch_scc1 LE_127
    s_mov_b32 s45, 0
LW_126:
    ds_read_b32 v2, v3 offset:32
    s_add_u32 s45, s45, 1
    s_cmp_gt_u32 s45, 0x80000
    s_cbranch_scc1 LE_127
    s_waitcnt lgkmcnt(0)
    v_readfirstlane_b32 s47, v2
    s_cmp_lt_i32 s47, 1
    s_cbranch_scc1 LW_126
LE_127:
    s_cmp_ge_i32 s44, s92
    s_cbranch_scc1 LE_129
    s_mov_b32 s45, 0
LW_128:
    ds_read_b32 v2, v3 offset:0
    s_add_u32 s45, s45, 1
    s_cmp_gt_u32 s45, 0x80000
    s_cbranch_scc1 LE_129
    s_waitcnt lgkmcnt(0)
    v_readfirstlane_b32 s44, v2
    s_cmp_lt_i32 s44, s92
    s_cbranch_scc1 LW_128
LE_129:
    ds_read_b128 v[16:19], v10 offset:0
    ds_read_b128 v[32:35], v10 offset:4352
    ds_read_b128 v[20:23], v10 offset:64
    ds_read_b128 v[36:39], v10 offset:4416
    ds_read_b128 v[24:27], v10 offset:128
    ds_read_b128 v[40:43], v10 offset:4480
    ds_read_b128 v[28:31], v10 offset:192
    ds_read_b128 v[44:47], v10 offset:4544
    s_waitcnt lgkmcnt(7)
    v_mfma_f32_16x16x32_bf16 v[64:67], v[16:19], v[48:51], v[64:67]
    s_waitcnt lgkmcnt(6)
    v_mfma_f32_16x16x32_bf16 v[68:71], v[32:35], v[48:51], v[68:71]
    s_waitcnt lgkmcnt(5)
    v_mfma_f32_16x16x32_bf16 v[64:67], v[20:23], v[52:55], v[64:67]
    s_waitcnt lgkmcnt(4)
    v_mfma_f32_16x16x32_bf16 v[68:71], v[36:39], v[52:55], v[68:71]
    s_waitcnt lgkmcnt(3)
    v_mfma_f32_16x16x32_bf16 v[64:67], v[24:27], v[56:59], v[64:67]
    s_waitcnt lgkmcnt(2)
    v_mfma_f32_16x16x32_bf16 v[68:71], v[40:43], v[56:59], v[68:71]
    s_waitcnt lgkmcnt(1)
    v_mfma_f32_16x16x32_bf16 v[64:67], v[28:31], v[60:63], v[64:67]
    s_waitcnt lgkmcnt(0)
    v_mfma_f32_16x16x32_bf16 v[68:71], v[44:47], v[60:63], v[68:71]
    s_nop 5
    v_cvt_pk_bf16_f32 v4, v64, v65
    v_and_b32 v5, s40, v4
    v_lshlrev_b32 v4, 16, v4
    v_mul_f32 v4, s41, v4
    v_mul_f32 v5, s41, v5
    v_cvt_pk_bf16_f32 v4, v4, v5
    v_and_b32 v65, s40, v4
    v_lshlrev_b32 v64, 16, v4
    v_cvt_pk_bf16_f32 v4, v66, v67
    v_and_b32 v5, s40, v4
    v_lshlrev_b32 v4, 16, v4
    v_mul_f32 v4, s41, v4
    v_mul_f32 v5, s41, v5
    v_cvt_pk_bf16_f32 v4, v4, v5
    v_and_b32 v67, s40, v4
    v_lshlrev_b32 v66, 16, v4
    v_cvt_pk_bf16_f32 v4, v68, v69
    v_and_b32 v5, s40, v4
    v_lshlrev_b32 v4, 16, v4
    v_mul_f32 v4, s41, v4
    v_mul_f32 v5, s41, v5
    v_cvt_pk_bf16_f32 v4, v4, v5
    v_and_b32 v69, s40, v4
    v_lshlrev_b32 v68, 16, v4
    v_cvt_pk_bf16_f32 v4, v70, v71
    v_and_b32 v5, s40, v4
    v_lshlrev_b32 v4, 16, v4
    v_mul_f32 v4, s41, v4
    v_mul_f32 v5, s41, v5
    v_cvt_pk_bf16_f32 v4, v4, v5
    v_and_b32 v71, s40, v4
    v_lshlrev_b32 v70, 16, v4
    v_max3_f32 v4, v64, v65, v66
    v_max3_f32 v5, v67, v68, v69
    v_max3_f32 v4, v4, v70, v71
    v_max_f32 v4, v4, v5
    v_mov_b32 v5, v4
    s_nop 1
    v_permlane16_swap_b32 v4, v5
    v_max_f32 v4, v4, v5
    v_mov_b32 v5, v4
    s_nop 1
    v_permlane32_swap_b32 v4, v5
    v_max_f32 v4, v4, v5
    ds_write_b32 v81, v4
    s_mov_b64 exec, 1
    v_mov_b32 v6, 1
    ds_add_u32 v3, v6 offset:20
    s_mov_b64 exec, -1
    s_mov_b32 s45, 0
LW_130:
    ds_read_b32 v2, v3 offset:20
    s_add_u32 s45, s45, 1
    s_cmp_gt_u32 s45, 0x80000
    s_cbranch_scc1 LE_131
    s_waitcnt lgkmcnt(0)
    v_readfirstlane_b32 s43, v2
    s_cmp_lt_i32 s43, 4
    s_cbranch_scc1 LW_130
LE_131:
    ds_read2_b32 v[4:5], v80 offset0:0 offset1:2
    ds_read2_b32 v[6:7], v80 offset0:4 offset1:6
    s_waitcnt lgkmcnt(0)
    v_max3_f32 v4, v4, v5, v6
    v_max_f32 v4, v4, v7
    v_mul_f32 v15, s42, v4
    v_fma_f32 v64, v64, s42, -v15
    v_fma_f32 v65, v65, s42, -v15
    v_fma_f32 v66, v66, s42, -v15
    v_fma_f32 v67, v67, s42, -v15
    v_fma_f32 v68, v68, s42, -v15
    v_fma_f32 v69, v69, s42, -v15
    v_fma_f32 v70, v70, s42, -v15
    v_fma_f32 v71, v71, s42, -v15
    v_exp_f32 v64, v64
    v_exp_f32 v65, v65
    v_exp_f32 v66, v66
    v_exp_f32 v67, v67
    v_exp_f32 v68, v68
    v_exp_f32 v69, v69
    v_exp_f32 v70, v70
    v_exp_f32 v71, v71
    v_cvt_pk_bf16_f32 v48, v64, v65
    v_cvt_pk_bf16_f32 v49, v66, v67
    v_cvt_pk_bf16_f32 v50, v68, v69
    v_cvt_pk_bf16_f32 v51, v70, v71
    ds_write_b128 v75, v[48:51] offset:4608
    v_add_f32 v5, v64, v65
    v_add_f32 v6, v66, v67
    v_add_f32 v5, v5, v68
    v_add_f32 v6, v6, v69
    v_add_f32 v5, v5, v70
    v_add_f32 v6, v6, v71
    v_add_f32 v5, v5, v6
    v_mov_b32 v6, v5
    s_nop 1
    v_permlane16_swap_b32 v5, v6
    v_add_f32 v5, v5, v6
    v_mov_b32 v6, v5
    s_nop 1
    v_permlane32_swap_b32 v5, v6
    v_add_f32 v5, v5, v6
    ds_write_b32 v81, v5 offset:32
    s_mov_b64 exec, 1
    v_mov_b32 v6, 1
    ds_add_u32 v3, v6 offset:8
    s_mov_b64 exec, -1
    v_mov_b32 v56, 0
    v_mov_b32 v57, 0
    v_mov_b32 v58, 0
    v_mov_b32 v59, 0
    v_mov_b32 v60, 0
    v_mov_b32 v61, 0
    v_mov_b32 v62, 0
    v_mov_b32 v63, 0
    s_sub_u32 s92, s36, 24
    s_mov_b32 s45, 0
LW_132:
    ds_read_b32 v2, v3 offset:8
    s_add_u32 s45, s45, 1
    s_cmp_gt_u32 s45, 0x80000
    s_cbranch_scc1 LE_133
    s_waitcnt lgkmcnt(0)
    v_readfirstlane_b32 s43, v2
    s_cmp_lt_i32 s43, 4
    s_cbranch_scc1 LW_132
LE_133:
    ds_read2_b32 v[4:5], v80 offset0:8 offset1:10
    ds_read2_b32 v[6:7], v80 offset0:12 offset1:14
    ds_read_b128 v[16:19], v74 offset:4608
    ds_read_b128 v[20:23], v74 offset:4736
    ds_read_b128 v[24:27], v74 offset:4864
    ds_read_b128 v[28:31], v74 offset:4992
    s_waitcnt lgkmcnt(4)
    v_add_f32 v4, v4, v5
    v_add_f32 v6, v6, v7
    v_add_f32 v4, v4, v6
    v_log_f32 v5, v4
    v_rcp_f32 v13, v4
    v_mov_b32 v50, s46
    v_mov_b32 v54, s46
    v_add_f32 v51, v15, v5
    v_add_f32 v55, v15, v5
    s_cmp_ge_i32 s44, s92
    s_cbranch_scc1 LE_135
    s_mov_b32 s45, 0
LW_134:
    ds_read_b32 v2, v3 offset:0
    s_add_u32 s45, s45, 1
    s_cmp_gt_u32 s45, 0x80000
    s_cbranch_scc1 LE_135
    s_waitcnt lgkmcnt(0)
    v_readfirstlane_b32 s44, v2
    s_cmp_lt_i32 s44, s92
    s_cbranch_scc1 LW_134
LE_135:
    ds_read_b64_tr_b16 v[32:33], v72 offset:0
    ds_read_b64_tr_b16 v[34:35], v72 offset:4608
    ds_read_b64_tr_b16 v[36:37], v73 offset:0
    ds_read_b64_tr_b16 v[38:39], v73 offset:4608
    s_add_u32 s92, s92, 8
    s_cmp_lt_i32 s44, s92
    s_cbranch_scc1 LS_136
LB_137:
    ds_read_b64_tr_b16 v[40:41], v72 offset:9216
    ds_read_b64_tr_b16 v[42:43], v72 offset:13824
    ds_read_b64_tr_b16 v[44:45], v73 offset:9216
    ds_read_b64_tr_b16 v[46:47], v73 offset:13824
    s_add_u32 s92, s92, 8
    s_waitcnt lgkmcnt(6)
    v_mfma_f32_16x16x32_bf16 v[56:59], v[32:35], v[16:19], v[56:59]
    s_waitcnt lgkmcnt(4)
    v_mfma_f32_16x16x32_bf16 v[60:63], v[36:39], v[16:19], v[60:63]
    s_cmp_lt_i32 s44, s92
    s_cbranch_scc1 LS_138
LB_139:
    ds_read_b64_tr_b16 v[32:33], v72 offset:18432
    ds_read_b64_tr_b16 v[34:35], v72 offset:23040
    ds_read_b64_tr_b16 v[36:37], v73 offset:18432
    ds_read_b64_tr_b16 v[38:39], v73 offset:23040
    s_add_u32 s92, s92, 8
    s_waitcnt lgkmcnt(6)
    v_mfma_f32_16x16x32_bf16 v[56:59], v[40:43], v[20:23], v[56:59]
    s_waitcnt lgkmcnt(4)
    v_mfma_f32_16x16x32_bf16 v[60:63], v[44:47], v[20:23], v[60:63]
    s_cmp_ge_i32 s44, s92
    s_cbranch_scc1 LE_141
    s_mov_b32 s45, 0
LW_140:
    ds_read_b32 v2, v3 offset:0
    s_add_u32 s45, s45, 1
    s_cmp_gt_u32 s45, 0x80000
    s_cbranch_scc1 LE_141
    s_waitcnt lgkmcnt(0)
    v_readfirstlane_b32 s44, v2
    s_cmp_lt_i32 s44, s92
    s_cbranch_scc1 LW_140
LE_141:
    ds_read_b64_tr_b16 v[40:41], v72 offset:27648
    ds_read_b64_tr_b16 v[42:43], v72 offset:32256
    ds_read_b64_tr_b16 v[44:45], v73 offset:27648
    ds_read_b64_tr_b16 v[46:47], v73 offset:32256
    s_waitcnt lgkmcnt(6)
    v_mfma_f32_16x16x32_bf16 v[56:59], v[32:35], v[24:27], v[56:59]
    s_waitcnt lgkmcnt(4)
    v_mfma_f32_16x16x32_bf16 v[60:63], v[36:39], v[24:27], v[60:63]
    s_waitcnt lgkmcnt(2)
    v_mfma_f32_16x16x32_bf16 v[56:59], v[40:43], v[28:31], v[56:59]
    s_waitcnt lgkmcnt(0)
    v_mfma_f32_16x16x32_bf16 v[60:63], v[44:47], v[28:31], v[60:63]
    s_mov_b64 exec, s[68:69]
    s_nop 4
    v_mul_f32 v56, v56, v13
    v_mul_f32 v57, v57, v13
    v_mul_f32 v58, v58, v13
    v_mul_f32 v59, v59, v13
    v_mul_f32 v60, v60, v13
    v_mul_f32 v61, v61, v13
    v_mul_f32 v62, v62, v13
    v_mul_f32 v63, v63, v13
    v_cvt_pk_bf16_f32 v48, v56, v57
    v_cvt_pk_bf16_f32 v49, v58, v59
    v_cvt_pk_bf16_f32 v52, v60, v61
    v_cvt_pk_bf16_f32 v53, v62, v63
    buffer_store_dwordx4 v[48:51], v1, s[60:63], s93 offen offset:0 sc1
    buffer_store_dwordx4 v[52:55], v1, s[60:63], s93 offen offset:128 sc1
    s_cmp_lg_u32 s47, 1
    s_cbranch_scc1 LS_142
    buffer_store_dwordx4 v[48:51], v1, s[64:67], s93 offen offset:0
    buffer_store_dwordx4 v[52:55], v1, s[64:67], s93 offen offset:128
LB_143:
    s_mov_b64 exec, -1
    s_cmp_ge_u32 s33, 16
    s_cbranch_scc1 L_a_red
    s_lshr_b32 s43, s33, 1
    s_cmp_eq_u32 s43, s28
    s_cselect_b32 s47, s47, 2
    s_min_u32 s92, s34, 154
    s_cmp_ge_i32 s44, s92
    s_cbranch_scc1 LE_145
    s_mov_b32 s45, 0
LW_144:
    ds_read_b32 v2, v3 offset:0
    s_add_u32 s45, s45, 1
    s_cmp_gt_u32 s45, 0x80000
    s_cbranch_scc1 LE_145
    s_waitcnt lgkmcnt(0)
    v_readfirstlane_b32 s44, v2
    s_cmp_lt_i32 s44, s92
    s_cbranch_scc1 LW_144
LE_145:
    s_mov_b32 s45, 0
L_a_opoll:
    s_cmp_eq_u32 s47, 1
    s_cbranch_scc1 L_a_oloc
    buffer_load_dwordx4 v[16:19], v82, s[60:63], s57 offen offset:0 sc1
    buffer_load_dwordx4 v[20:23], v82, s[60:63], s57 offen offset:1024 sc1
    buffer_load_dwordx4 v[24:27], v82, s[60:63], s57 offen offset:2048 sc1
    buffer_load_dwordx4 v[28:31], v82, s[60:63], s57 offen offset:3072 sc1
L_a_ochk:
    s_add_u32 s45, s45, 1
    s_cmp_gt_u32 s45, 0x8000
    s_cbranch_scc1 L_a_ook
    s_waitcnt vmcnt(0)
    v_xor_b32 v4, s46, v18
    v_xor_b32 v5, s46, v22
    v_xor_b32 v6, s46, v26
    v_xor_b32 v7, s46, v30
    v_or3_b32 v4, v4, v5, v6
    v_or_b32 v4, v4, v7
    v_cmp_ne_u32 vcc, 0, v4
    s_and_b64 exec, exec, vcc
    s_cbranch_vccnz L_a_opoll
L_a_ook:
    s_mov_b64 exec, -1
    s_waitcnt vmcnt(0)
    v_max3_f32 v4, v19, v23, v27
    v_max_f32 v4, v4, v31
    v_mov_b32 v5, v4
    v_lshlrev_b32 v32, 16, v16
    v_and_b32 v33, s40, v16
    v_permlane32_swap_b32 v4, v5
    v_max_f32 v4, v4, v5
    v_sub_f32 v19, v19, v4
    v_sub_f32 v23, v23, v4
    v_sub_f32 v27, v27, v4
    v_sub_f32 v31, v31, v4
    v_exp_f32 v19, v19
    v_exp_f32 v23, v23
    v_exp_f32 v27, v27
    v_exp_f32 v31, v31
    v_lshlrev_b32 v34, 16, v17
    v_and_b32 v35, s40, v17
    v_mul_f32 v32, v32, v19
    v_mul_f32 v33, v33, v19
    v_mul_f32 v34, v34, v19
    v_mul_f32 v35, v35, v19
    v_add_f32 v5, v19, v23
    v_add_f32 v6, v27, v31
    v_add_f32 v5, v5, v6
    v_mov_b32 v4, v5
    v_lshlrev_b32 v6, 16, v20
    v_and_b32 v7, s40, v20
    v_fmac_f32 v32, v23, v6
    v_fmac_f32 v33, v23, v7
    v_permlane32_swap_b32 v4, v5
    v_add_f32 v4, v4, v5
    v_rcp_f32 v4, v4
    v_lshlrev_b32 v6, 16, v21
    v_and_b32 v7, s40, v21
    v_fmac_f32 v34, v23, v6
    v_fmac_f32 v35, v23, v7
    v_lshlrev_b32 v6, 16, v24
    v_and_b32 v7, s40, v24
    v_fmac_f32 v32, v27, v6
    v_fmac_f32 v33, v27, v7
    v_lshlrev_b32 v6, 16, v25
    v_and_b32 v7, s40, v25
    v_fmac_f32 v34, v27, v6
    v_fmac_f32 v35, v27, v7
    v_lshlrev_b32 v6, 16, v28
    v_and_b32 v7, s40, v28
    v_fmac_f32 v32, v31, v6
    v_fmac_f32 v33, v31, v7
    v_lshlrev_b32 v6, 16, v29
    v_and_b32 v7, s40, v29
    v_fmac_f32 v34, v31, v6
    v_fmac_f32 v35, v31, v7
    s_nop 1
    v_permlane32_swap_b32 v32, v34
    v_permlane32_swap_b32 v33, v35
    v_add_f32 v32, v32, v34
    v_add_f32 v33, v33, v35
    v_mul_f32 v32, v32, v4
    v_mul_f32 v33, v33, v4
    v_cvt_pk_bf16_f32 v32, v32, v33
    ds_write_b32 v83, v32 offset:3072
    s_waitcnt lgkmcnt(0)
    s_barrier
    s_branch L_a_end
L_a_red:
    s_sub_u32 s40, s29, 28
    s_lshl2_add_u32 s56, s28, s40
    s_cmp_lt_u32 s40, 4
    s_cbranch_scc1 L_a_red2
    s_sub_u32 s40, s29, 24
    s_add_u32 s56, s40, 32
    s_cmp_ge_u32 s40, 4
    s_cbranch_scc1 L_a_end
    s_cmp_lg_u32 s28, 7
    s_cbranch_scc1 L_a_end
L_a_red2:
    s_sub_u32 s92, s34, 12
    s_cmp_ge_i32 s44, s92
    s_cbranch_scc1 LE_147
    s_mov_b32 s45, 0
LW_146:
    ds_read_b32 v2, v3 offset:0
    s_add_u32 s45, s45, 1
    s_cmp_gt_u32 s45, 0x80000
    s_cbranch_scc1 LE_147
    s_waitcnt lgkmcnt(0)
    v_readfirstlane_b32 s44, v2
    s_cmp_lt_i32 s44, s92
    s_cbranch_scc1 LW_146
LE_147:
    s_mov_b32 s52, s22
    s_mov_b32 s53, s23
    s_mov_b32 s54, 0x900
    s_mov_b32 s55, 0x00020000
    v_and_b32 v11, 1, v0
    v_lshlrev_b32 v12, 3, v11
    v_and_b32 v10, 1, v8
    v_lshl_add_u32 v12, v10, 2, v12
    s_lshr_b32 s41, s90, 1
    s_mul_i32 s41, s41, 1152
    s_and_b32 s42, s90, 1
    s_lshl4_add_u32 s41, s42, s41
    s_lshl_b32 s42, s56, 5
    s_add_u32 s41, s41, s42
    v_add_u32 v12, s41, v12
    global_load_dword v40, v12, s[4:5]
    s_lshl_b32 s40, s56, 12
    s_lshl_b32 s42, s90, 5
    s_add_u32 s40, s40, s42
    s_add_u32 s40, s40, 1273856
    v_lshrrev_b32 v10, 1, v0
    v_lshlrev_b32 v11, 4, v11
    v_lshl_add_u32 v11, v10, 7, v11
    s_mov_b32 s41, 0xffff0000
    s_mov_b32 s45, 0
    s_waitcnt vmcnt(0)
    v_and_b32 v41, s41, v40
    v_lshlrev_b32 v40, 16, v40
L_a_fpoll:
    s_cmp_lg_u32 s47, 1
    s_cbranch_scc1 LS_148
    buffer_load_dwordx4 v[16:19], v11, s[64:67], s40 offen nt
LB_149:
    s_add_u32 s45, s45, 1
    s_cmp_gt_u32 s45, 0x8000
    s_cbranch_scc1 L_a_fok
    s_waitcnt vmcnt(0)
    v_xor_b32 v16, s94, v16
    v_xor_b32 v17, s95, v17
    v_xor_b32 v18, s96, v18
    v_xor_b32 v19, s97, v19
    v_or3_b32 v4, v16, v17, v18
    v_or_b32 v4, v4, v19
    v_and_b32 v4, 0xff, v4
    v_cmp_ne_u32 vcc, 0, v4
    s_and_b64 exec, exec, vcc
    s_cbranch_vccnz L_a_fpoll
L_a_fok:
    s_mov_b64 exec, -1
    v_permlane16_swap_b32 v16, v18
    v_permlane16_swap_b32 v17, v19
    v_add_f32 v16, v16, v18
    v_add_f32 v17, v17, v19
    s_nop 0
    v_add_f32_dpp v16, v16, v16 quad_perm:[2,3,0,1] row_mask:0xf bank_mask:0xf
    v_add_f32_dpp v17, v17, v17 quad_perm:[2,3,0,1] row_mask:0xf bank_mask:0xf
    s_nop 0
    v_add_f32_dpp v16, v16, v16 row_ror:4 row_mask:0xf bank_mask:0xf
    v_add_f32_dpp v17, v17, v17 row_ror:4 row_mask:0xf bank_mask:0xf
    s_nop 0
    v_add_f32_dpp v16, v16, v16 row_ror:8 row_mask:0xf bank_mask:0xf
    v_add_f32_dpp v17, v17, v17 row_ror:8 row_mask:0xf bank_mask:0xf
    v_cvt_pk_bf16_f32 v16, v16, v17
    v_mov_b32 v18, v16
    s_nop 1
    v_permlane32_swap_b32 v16, v18
    v_lshlrev_b32 v6, 16, v16
    v_and_b32 v7, s41, v16
    v_add_f32 v4, v40, v6
    v_add_f32 v5, v41, v7
    v_cvt_pk_bf16_f32 v4, v4, v5
    v_lshlrev_b32 v6, 16, v18
    v_and_b32 v7, s41, v18
    v_and_b32 v5, s41, v4
    v_lshlrev_b32 v4, 16, v4
    s_mov_b64 exec, 0x30003
    v_add_f32 v4, v4, v6
    v_add_f32 v5, v5, v7
    v_cvt_pk_bf16_f32 v20, v4, v5
    buffer_store_dword v20, v12, s[52:55], 0 offen
    s_or_b32 s56, s56, s90
    s_cmp_lg_u32 s56, 0
    s_cbranch_scc1 L_a_end
    s_mov_b64 exec, 1
    v_mov_b32 v4, s46
    buffer_store_dword v4, v3, s[64:67], 0 offen
L_a_end:
L_end:
    s_endpgm
LS_120:
    buffer_load_dwordx4 v[16:19], v11, s[60:63], s40 offen offset:0 sc1
    buffer_load_dwordx4 v[20:23], v11, s[60:63], s40 offen offset:2048 sc1
    buffer_load_dwordx4 v[24:27], v11, s[60:63], s41 offen offset:0 sc1
    buffer_load_dwordx4 v[28:31], v11, s[60:63], s41 offen offset:2048 sc1
    s_branch LB_121
LS_136:
    s_cmp_ge_i32 s44, s92
    s_cbranch_scc1 LE_151
    s_mov_b32 s45, 0
LW_150:
    ds_read_b32 v2, v3 offset:0
    s_add_u32 s45, s45, 1
    s_cmp_gt_u32 s45, 0x80000
    s_cbranch_scc1 LE_151
    s_waitcnt lgkmcnt(0)
    v_readfirstlane_b32 s44, v2
    s_cmp_lt_i32 s44, s92
    s_cbranch_scc1 LW_150
LE_151:
    s_branch LB_137
LS_138:
    s_cmp_ge_i32 s44, s92
    s_cbranch_scc1 LE_153
    s_mov_b32 s45, 0
LW_152:
    ds_read_b32 v2, v3 offset:0
    s_add_u32 s45, s45, 1
    s_cmp_gt_u32 s45, 0x80000
    s_cbranch_scc1 LE_153
    s_waitcnt lgkmcnt(0)
    v_readfirstlane_b32 s44, v2
    s_cmp_lt_i32 s44, s92
    s_cbranch_scc1 LW_152
LE_153:
    s_branch LB_139
LS_142:
    s_branch LB_143
L_a_oloc:
    buffer_load_dwordx4 v[16:19], v82, s[64:67], s57 offen offset:0 nt
    buffer_load_dwordx4 v[20:23], v82, s[64:67], s57 offen offset:1024 nt
    buffer_load_dwordx4 v[24:27], v82, s[64:67], s57 offen offset:2048 nt
    buffer_load_dwordx4 v[28:31], v82, s[64:67], s57 offen offset:3072 nt
    s_branch L_a_ochk
LS_148:
    buffer_load_dwordx4 v[16:19], v11, s[64:67], s40 offen sc1
    s_branch LB_149
L_code_end:
    .fill 256, 4, 0xbf800000
.section .rodata,"a"
.p2align 6
.amdhsa_kernel parallel_sum__sliding_block_cached__geglu_ffn__decode_kernel
  .amdhsa_next_free_vgpr 152
  .amdhsa_next_free_sgpr 102
  .amdhsa_accum_offset 152
  .amdhsa_group_segment_fixed_size 0
  .amdhsa_kernarg_size 96
  .amdhsa_user_sgpr_count 2
  .amdhsa_user_sgpr_kernarg_segment_ptr 1
  .amdhsa_system_sgpr_workgroup_id_x 1
  .amdhsa_float_denorm_mode_32 3
.end_amdhsa_kernel
```
